```python
import torch

def _softmax(x, axis=-1):
    return torch.softmax(x, dim=axis)
def _gelu(x):
    return torch.nn.functional.gelu(x, approximate="tanh")
def _silu(x):
    return torch.nn.functional.silu(x)
def _sigmoid(x):
    return torch.sigmoid(x)
def _layernorm(x, axis=-1, eps=1e-5):
    m = x.mean(dim=axis, keepdim=True)
    v = x.var(dim=axis, keepdim=True, unbiased=False)
    return (x - m) / torch.sqrt(v + eps)
def _scatter_add(tgt, idx, src, axis=0):
    return tgt.clone().index_add_(axis, idx, src)
def _segment_sum(src, seg, n):
    out = torch.zeros((n,) + src.shape[1:], dtype=src.dtype)
    return out.index_add_(0, seg, src)
def _pad(x, pw):
    flat = tuple(v for pair in reversed(pw) for v in pair)
    return torch.nn.functional.pad(x, flat)

kernel_name = 'concat_heads__compressed_kv_cla__sliding_block_cached__decode'

def setup_inputs():

    _w = (lambda a: (lambda t: t.to(torch.bfloat16) if t.is_floating_point() else t)(torch.as_tensor(a)))
    def _A_setup():
        B, H, Sq, Sk, D, M = 4, 32, 1, 4096, 128, 512
        Dc = 4 * D
        return {
            "x": _w((lambda *s: torch.randn(*s, dtype=torch.bfloat16) * 3.2)(B, Sq, M)),
            "c_kv": _w((lambda *s: torch.randn(*s, dtype=torch.bfloat16) * 0.1)(B, Sk, Dc)),
            "w_q": _w((lambda *s: torch.randn(*s, dtype=torch.bfloat16) * 6.4)(M, H, D) * (M ** -0.5)),
            "w_uk": _w((lambda *s: torch.randn(*s, dtype=torch.bfloat16) * 6.4)(Dc, H, D) * (Dc ** -0.5)),
            "w_uv": _w((lambda *s: torch.randn(*s, dtype=torch.bfloat16) * 0.1)(Dc, H, D) * (Dc ** -0.5)),
            "w_o": _w((lambda *s: torch.randn(*s, dtype=torch.bfloat16) * 0.1)(H, D, M) * ((H * D) ** -0.5)),
        }
    _A_in = _A_setup()

    def _B_setup():
        B, Sq, D = 4, 1, 512
        Hq, Hkv, Sk, Dh = 32, 8, 4096, 128
        assert Hq % Hkv == 0, (Hq, Hkv)
        return {
            "x": _w((lambda *s: torch.randn(*s, dtype=torch.bfloat16) * 1.6)(B, Sq, D)),
            "k_cache": _w((lambda *s: torch.randn(*s, dtype=torch.bfloat16) * 1.6)(B, Hkv, Sk, Dh)),
            "v_cache": _w((lambda *s: torch.randn(*s, dtype=torch.bfloat16) * 0.05)(B, Hkv, Sk, Dh)),
            "wq": _w((lambda *s: torch.randn(*s, dtype=torch.bfloat16) * 1.6)(D, Hq * Dh) * (D ** -0.5)),
            "wo": _w((lambda *s: torch.randn(*s, dtype=torch.bfloat16) * 0.05)(Hq * Dh, D) * ((Hq * Dh) ** -0.5)),
        }
    _B_in = _B_setup()

    return {
        "A_x": _A_in["x"],
        "A_c_kv": _A_in["c_kv"],
        "A_w_q": _A_in["w_q"],
        "A_w_uk": _A_in["w_uk"],
        "A_w_uv": _A_in["w_uv"],
        "A_w_o": _A_in["w_o"],
        "B_x": _B_in["x"],
        "B_k_cache": _B_in["k_cache"],
        "B_v_cache": _B_in["v_cache"],
        "B_wq": _B_in["wq"],
        "B_wo": _B_in["wo"],
    }

def reference(A_x, A_c_kv, A_w_q, A_w_uk, A_w_uv, A_w_o, B_x, B_k_cache, B_v_cache, B_wq, B_wo):
    def _A_ref(x, c_kv, w_q, w_uk, w_uv, w_o):
        B, Sq, M = x.shape[0], x.shape[1], x.shape[2]
        Sk = c_kv.shape[1]
        H, D = w_q.shape[1], w_q.shape[2]
        q = torch.einsum("bqm,mhd->bhqd", x, w_q)
        k = torch.einsum("bkc,chd->bhkd", c_kv, w_uk)
        v = torch.einsum("bkc,chd->bhkd", c_kv, w_uv)
        scores = torch.einsum("bhqd,bhkd->bhqk", q, k) * (D ** -0.5)
        off = Sk - Sq
        qi = torch.arange(Sq)[:, None]
        kj = torch.arange(Sk)[None, :]
        cmask = kj <= (qi + off)
        scores = torch.where(cmask[None, None], scores, -1e9)
        p = _softmax(scores, axis=-1)
        ctx = torch.einsum("bhqk,bhkd->bhqd", p, v)
        return torch.einsum("bhqd,hdm->bqm", ctx, w_o)

    def _B_ref(x, k_cache, v_cache, wq, wo):
        B, Sq, D = x.shape
        Hq, Dh = 32, 128
        Hkv, Sk = k_cache.shape[1], k_cache.shape[2]
        W = min(4096, max(256, Sk // 4))
        rep = Hq // Hkv
        q = (lambda x, *d: x.permute(*d))((x @ wq).reshape(B, Sq, Hq, Dh), 0, 2, 1, 3)
        k = (lambda x, n, axis: torch.repeat_interleave(x, n, dim=axis))(k_cache[:, :, Sk - W:, :], rep, axis=1)
        v = (lambda x, n, axis: torch.repeat_interleave(x, n, dim=axis))(v_cache[:, :, Sk - W:, :], rep, axis=1)
        scores = torch.einsum("bhqd,bhkd->bhqk", q, k) * (Dh ** -0.5)
        p = _softmax(scores, axis=-1)
        o = torch.einsum("bhqk,bhkd->bhqd", p, v)
        return (lambda x, *d: x.permute(*d))(o, 0, 2, 1, 3).reshape(B, Sq, Hq * Dh) @ wo

    a = _A_ref(A_x, A_c_kv, A_w_q, A_w_uk, A_w_uv, A_w_o)
    b = _B_ref(B_x, B_k_cache, B_v_cache, B_wq, B_wo)
    return torch.concatenate([a, b], axis=-1)
```

```asm
; @launch grid=(256,1,1) block=(512,1,1) lds=163840
.amdgcn_target "amdgcn-amd-amdhsa--gfx950"
.text
.globl concat_heads__compressed_kv_cla__sliding_block_cached__decode_kernel
.p2align 8
.type concat_heads__compressed_kv_cla__sliding_block_cached__decode_kernel,@function
concat_heads__compressed_kv_cla__sliding_block_cached__decode_kernel:
    s_cmp_ge_u32 s2, 256
    s_cbranch_scc1 L_end
    s_load_dwordx16 s[4:19], s[0:1], 0
    s_load_dwordx8 s[20:27], s[0:1], 64
    s_load_dwordx4 s[28:31], s[0:1], 96
    v_lshrrev_b32 v1, 6, v0
    s_and_b32 s34, s2, 7
    v_readfirstlane_b32 s3, v1
    s_lshr_b32 s35, s2, 3
    v_and_b32 v1, 63, v0
    s_and_b32 s32, s35, 3
    s_lshl_b32 s36, s34, 2
    s_add_u32 s32, s32, s36
    s_lshr_b32 s33, s35, 2
    v_lshrrev_b32 v10, 4, v1
    v_and_b32 v11, 15, v1
    v_lshrrev_b32 v17, 3, v11
    v_lshlrev_b32 v17, 10, v17
    v_lshl_add_u32 v17, v10, 3, v17
    v_lshlrev_b32 v18, 15, v10
    v_lshl_add_u32 v18, v11, 4, v18
    s_and_b32 s36, s33, 3
    s_lshl_b32 s36, s36, 3
    s_add_u32 s41, s36, s3
    s_mov_b32 s43, s41
    s_lshl_b32 s37, s41, 5
    s_add_u32 s38, s37, 2048
    s_lshl_b32 s39, s41, 17
    s_lshl_b32 s40, s32, 8
    s_add_u32 s39, s39, s40
    s_mov_b32 s54, 0x400000
    s_mov_b32 s55, 0x20000
    s_mov_b32 s62, 4096
    s_mov_b32 s63, 0x20000
    s_waitcnt lgkmcnt(0)
    s_cmp_lt_u32 s35, 16
    s_cbranch_scc1 roleA_1
    s_mov_b32 s60, s4
    s_and_b32 s61, s5, 0xffff
    s_mov_b32 s52, s8
    s_and_b32 s53, s9, 0xffff
    buffer_load_dwordx2 v[20:21], v17, s[60:63], s37 offen
    buffer_load_dwordx2 v[22:23], v17, s[60:63], s38 offen
    buffer_load_dwordx4 v[24:27], v18, s[52:55], s39 offen nt
    s_add_u32 s37, s39, 8192
    buffer_load_dwordx4 v[28:31], v18, s[52:55], s37 offen nt
    s_add_u32 s37, s39, 16384
    buffer_load_dwordx4 v[32:35], v18, s[52:55], s37 offen nt
    s_add_u32 s37, s39, 24576
    buffer_load_dwordx4 v[36:39], v18, s[52:55], s37 offen nt
    s_branch roleB1_5
roleA_1:
    s_lshr_b32 s66, s34, 1
    s_and_b32 s67, s34, 1
    s_lshl_b32 s67, s67, 4
    s_add_u32 s67, s67, s35
    s_lshl_b32 s36, s66, 22
    s_lshl_b32 s40, s67, 17
    s_add_u32 s36, s36, s40
    s_add_u32 s48, s6, s36
    s_addc_u32 s49, s7, 0
    s_and_b32 s49, s49, 0xffff
    s_mov_b32 s50, 0x20000
    s_mov_b32 s51, 0x20000
    v_lshlrev_b32 v19, 4, v1
    s_lshl_b32 s36, s3, 14
    s_mov_b32 s60, s16
    s_and_b32 s61, s17, 0xffff
    s_mov_b32 s52, s22
    s_and_b32 s53, s23, 0xffff
    buffer_load_dwordx2 v[20:21], v17, s[60:63], s37 offen
    buffer_load_dwordx2 v[22:23], v17, s[60:63], s38 offen
    buffer_load_dwordx4 v[24:27], v18, s[52:55], s39 offen nt
    s_add_u32 s37, s39, 8192
    buffer_load_dwordx4 v[28:31], v18, s[52:55], s37 offen nt
    s_add_u32 s37, s39, 16384
    buffer_load_dwordx4 v[32:35], v18, s[52:55], s37 offen nt
    s_add_u32 s37, s39, 24576
    buffer_load_dwordx4 v[36:39], v18, s[52:55], s37 offen nt
    v_xor_b32 v44, 0, v19
    s_add_u32 s40, s36, 0
    s_mov_b32 m0, s40
    s_nop 0
    buffer_load_dwordx4 v44, s[48:51], s40 offen nt lds
    v_xor_b32 v45, 64, v19
    s_add_u32 s40, s36, 1024
    s_mov_b32 m0, s40
    s_nop 0
    buffer_load_dwordx4 v45, s[48:51], s40 offen nt lds
    v_xor_b32 v44, 128, v19
    s_add_u32 s40, s36, 2048
    s_mov_b32 m0, s40
    s_nop 0
    buffer_load_dwordx4 v44, s[48:51], s40 offen nt lds
    v_xor_b32 v45, 192, v19
    s_add_u32 s40, s36, 3072
    s_mov_b32 m0, s40
    s_nop 0
    buffer_load_dwordx4 v45, s[48:51], s40 offen nt lds
    v_xor_b32 v44, 16, v19
    s_add_u32 s40, s36, 4096
    s_mov_b32 m0, s40
    s_nop 0
    buffer_load_dwordx4 v44, s[48:51], s40 offen nt lds
    v_xor_b32 v45, 80, v19
    s_add_u32 s40, s36, 5120
    s_mov_b32 m0, s40
    s_nop 0
    buffer_load_dwordx4 v45, s[48:51], s40 offen nt lds
    v_xor_b32 v44, 144, v19
    s_add_u32 s40, s36, 6144
    s_mov_b32 m0, s40
    s_nop 0
    buffer_load_dwordx4 v44, s[48:51], s40 offen nt lds
    v_xor_b32 v45, 208, v19
    s_add_u32 s40, s36, 7168
    s_mov_b32 m0, s40
    s_nop 0
    buffer_load_dwordx4 v45, s[48:51], s40 offen nt lds
    v_xor_b32 v44, 32, v19
    s_add_u32 s40, s36, 8192
    s_mov_b32 m0, s40
    s_nop 0
    buffer_load_dwordx4 v44, s[48:51], s40 offen nt lds
    v_xor_b32 v45, 96, v19
    s_add_u32 s40, s36, 9216
    s_mov_b32 m0, s40
    s_nop 0
    buffer_load_dwordx4 v45, s[48:51], s40 offen nt lds
    v_xor_b32 v44, 160, v19
    s_add_u32 s40, s36, 10240
    s_mov_b32 m0, s40
    s_nop 0
    buffer_load_dwordx4 v44, s[48:51], s40 offen nt lds
    v_xor_b32 v45, 224, v19
    s_add_u32 s40, s36, 11264
    s_mov_b32 m0, s40
    s_nop 0
    buffer_load_dwordx4 v45, s[48:51], s40 offen nt lds
    v_xor_b32 v44, 48, v19
    s_add_u32 s40, s36, 12288
    s_mov_b32 m0, s40
    s_nop 0
    buffer_load_dwordx4 v44, s[48:51], s40 offen nt lds
    v_xor_b32 v45, 112, v19
    s_add_u32 s40, s36, 13312
    s_mov_b32 m0, s40
    s_nop 0
    buffer_load_dwordx4 v45, s[48:51], s40 offen nt lds
    v_xor_b32 v44, 176, v19
    s_add_u32 s40, s36, 14336
    s_mov_b32 m0, s40
    s_nop 0
    buffer_load_dwordx4 v44, s[48:51], s40 offen nt lds
    v_xor_b32 v45, 240, v19
    s_add_u32 s40, s36, 15360
    s_mov_b32 m0, s40
    s_nop 0
    buffer_load_dwordx4 v45, s[48:51], s40 offen nt lds
    s_branch roleA1_6
roleB1_5:
    s_barrier
    s_mov_b32 s56, s10
    s_and_b32 s57, s11, 0xffff
    s_mov_b32 s58, 0x400000
    s_mov_b32 s59, 0x20000
    s_lshl_b32 s36, s3, 12
    s_add_u32 s36, s36, 98304
    v_add_u32 v96, 0, v10
    v_xor_b32 v96, v96, v11
    v_lshlrev_b32 v96, 4, v96
    v_lshl_add_u32 v100, v10, 13, v96
    s_add_u32 s37, s36, 0
    s_mov_b32 m0, s37
    s_add_u32 s38, s39, 0
    buffer_load_dwordx4 v100, s[56:59], s38 offen nt lds
    v_add_u32 v96, 4, v10
    v_xor_b32 v96, v96, v11
    v_lshlrev_b32 v96, 4, v96
    v_lshl_add_u32 v101, v10, 13, v96
    s_add_u32 s37, s36, 1024
    s_mov_b32 m0, s37
    s_add_u32 s38, s39, 32768
    buffer_load_dwordx4 v101, s[56:59], s38 offen nt lds
    v_add_u32 v96, 8, v10
    v_xor_b32 v96, v96, v11
    v_lshlrev_b32 v96, 4, v96
    v_lshl_add_u32 v102, v10, 13, v96
    s_add_u32 s37, s36, 2048
    s_mov_b32 m0, s37
    s_add_u32 s38, s39, 65536
    buffer_load_dwordx4 v102, s[56:59], s38 offen nt lds
    v_add_u32 v96, 12, v10
    v_xor_b32 v96, v96, v11
    v_lshlrev_b32 v96, 4, v96
    v_lshl_add_u32 v103, v10, 13, v96
    s_add_u32 s37, s36, 3072
    s_mov_b32 m0, s37
    s_add_u32 s38, s39, 98304
    buffer_load_dwordx4 v103, s[56:59], s38 offen nt lds
    s_load_dword s71, s[30:31], 0
    s_mov_b32 s44, s30
    s_and_b32 s45, s31, 0xffff
    s_mov_b32 s46, 0x10000000
    s_mov_b32 s47, 0x20000
    s_lshl_b32 s72, s32, 1
    s_bfe_u32 s36, s33, 0x10001
    s_add_u32 s72, s72, s36
    s_and_b32 s73, s33, 1
    v_bfe_u32 v44, v1, 1, 2
    v_and_b32 v45, 1, v1
    v_lshlrev_b32 v45, 4, v45
    v_cmp_eq_u32 s[64:65], 0, v44
    v_cmp_eq_u32 s[74:75], 1, v44
    v_cmp_eq_u32 s[76:77], 2, v44
    v_cmp_eq_u32 s[78:79], 3, v44
    v_mov_b32 v46, 0x0c0c0100
    v_alignbit_b32 v46, v46, v46, v45
    v_mov_b32 v47, 0x0c0c0302
    v_alignbit_b32 v47, v47, v47, v45
    v_mov_b32 v44, 0x0c0c0c0c
    v_cndmask_b32 v2, v44, v46, s[64:65]
    v_cndmask_b32 v3, v44, v47, s[64:65]
    v_cndmask_b32 v4, v44, v46, s[74:75]
    v_cndmask_b32 v5, v44, v47, s[74:75]
    v_cndmask_b32 v6, v44, v46, s[76:77]
    v_cndmask_b32 v7, v44, v47, s[76:77]
    v_cndmask_b32 v8, v44, v46, s[78:79]
    v_cndmask_b32 v9, v44, v47, s[78:79]
    v_mov_b32 v44, 0x3f803f80
    v_perm_b32 v12, v44, v44, v2
    v_perm_b32 v13, v44, v44, v4
    v_perm_b32 v14, v44, v44, v6
    v_perm_b32 v15, v44, v44, v8
    v_lshrrev_b32 v19, 5, v1
    v_mul_u32_u24 v19, 768, v19
    v_lshl_add_u32 v19, v11, 4, v19
    v_and_b32 v56, 1, v10
    v_mul_u32_u24 v56, 384, v56
    v_add_u32 v19, v19, v56
    s_mul_i32 s36, s3, 3072
    s_add_u32 s36, s36, 0x20000
    v_add_u32 v19, s36, v19
    v_lshlrev_b32 v57, 4, v0
    v_bfe_u32 v58, v0, 5, 2
    v_mul_u32_u24 v58, 768, v58
    v_and_b32 v56, 1, v0
    v_mul_u32_u24 v56, 384, v56
    v_add_u32 v58, v58, v56
    v_bfe_u32 v56, v0, 1, 4
    v_lshl_add_u32 v58, v56, 4, v58
    v_add_u32 v58, 0x20000, v58
    s_lshl_b32 s40, s32, 2
    s_and_b32 s37, s33, 3
    s_add_u32 s40, s40, s37
    s_lshl_b32 s40, s40, 11
    s_add_u32 s40, s40, 0x100000
    s_waitcnt lgkmcnt(0)
    s_add_u32 s71, s71, 1
    s_and_b32 s70, s71, 0x3fff
    s_bfe_u32 s36, s71, 0xe000e
    s_lshl_b32 s36, s36, 16
    s_or_b32 s70, s70, s36
    v_mov_b32 v16, s70
    s_waitcnt vmcnt(8)
    v_perm_b32 v128, v20, v20, v2
    v_perm_b32 v129, v20, v20, v4
    v_perm_b32 v130, v20, v20, v6
    v_perm_b32 v131, v20, v20, v8
    v_perm_b32 v132, v22, v22, v2
    v_perm_b32 v133, v22, v22, v4
    v_perm_b32 v134, v22, v22, v6
    v_perm_b32 v135, v22, v22, v8
    v_perm_b32 v136, v20, v20, v3
    v_perm_b32 v137, v20, v20, v5
    v_perm_b32 v138, v20, v20, v7
    v_perm_b32 v139, v20, v20, v9
    v_perm_b32 v140, v22, v22, v3
    v_perm_b32 v141, v22, v22, v5
    v_perm_b32 v142, v22, v22, v7
    v_perm_b32 v143, v22, v22, v9
    v_perm_b32 v144, v21, v21, v2
    v_perm_b32 v145, v21, v21, v4
    v_perm_b32 v146, v21, v21, v6
    v_perm_b32 v147, v21, v21, v8
    v_perm_b32 v148, v23, v23, v2
    v_perm_b32 v149, v23, v23, v4
    v_perm_b32 v150, v23, v23, v6
    v_perm_b32 v151, v23, v23, v8
    v_perm_b32 v152, v21, v21, v3
    v_perm_b32 v153, v21, v21, v5
    v_perm_b32 v154, v21, v21, v7
    v_perm_b32 v155, v21, v21, v9
    v_perm_b32 v156, v23, v23, v3
    v_perm_b32 v157, v23, v23, v5
    v_perm_b32 v158, v23, v23, v7
    v_perm_b32 v159, v23, v23, v9
    s_waitcnt vmcnt(7)
    v_mfma_f32_16x16x32_bf16 v[40:43], v[128:131], v[24:27], 0
    v_mfma_f32_16x16x32_bf16 v[44:47], v[132:135], v[24:27], 0
    s_waitcnt vmcnt(6)
    v_mfma_f32_16x16x32_bf16 v[40:43], v[136:139], v[28:31], v[40:43]
    v_mfma_f32_16x16x32_bf16 v[44:47], v[140:143], v[28:31], v[44:47]
    s_waitcnt vmcnt(5)
    v_mfma_f32_16x16x32_bf16 v[40:43], v[144:147], v[32:35], v[40:43]
    v_mfma_f32_16x16x32_bf16 v[44:47], v[148:151], v[32:35], v[44:47]
    s_waitcnt vmcnt(4)
    v_mfma_f32_16x16x32_bf16 v[40:43], v[152:155], v[36:39], v[40:43]
    v_mfma_f32_16x16x32_bf16 v[44:47], v[156:159], v[36:39], v[44:47]
    s_nop 6
    ds_write_b128 v19, v[40:43] offset:0
    ds_write_b128 v19, v[44:47] offset:1536
    s_waitcnt lgkmcnt(0)
    s_barrier
    s_cmp_ge_u32 s3, 2
    s_cbranch_scc1 nopub_7
    ds_read_b128 v[60:63], v58 offset:0
    ds_read_b128 v[64:67], v58 offset:3072
    ds_read_b128 v[68:71], v58 offset:6144
    ds_read_b128 v[72:75], v58 offset:9216
    ds_read_b128 v[76:79], v58 offset:12288
    ds_read_b128 v[80:83], v58 offset:15360
    ds_read_b128 v[84:87], v58 offset:18432
    ds_read_b128 v[88:91], v58 offset:21504
    v_mov_b32 v94, v16
    v_mov_b32 v95, 0
    s_waitcnt lgkmcnt(4)
    v_pk_add_f32 v[60:61], v[60:61], v[64:65]
    v_pk_add_f32 v[62:63], v[62:63], v[66:67]
    v_pk_add_f32 v[68:69], v[68:69], v[72:73]
    v_pk_add_f32 v[70:71], v[70:71], v[74:75]
    v_pk_add_f32 v[60:61], v[60:61], v[68:69]
    v_pk_add_f32 v[62:63], v[62:63], v[70:71]
    s_waitcnt lgkmcnt(0)
    v_pk_add_f32 v[76:77], v[76:77], v[80:81]
    v_pk_add_f32 v[78:79], v[78:79], v[82:83]
    v_pk_add_f32 v[84:85], v[84:85], v[88:89]
    v_pk_add_f32 v[86:87], v[86:87], v[90:91]
    v_pk_add_f32 v[76:77], v[76:77], v[84:85]
    v_pk_add_f32 v[78:79], v[78:79], v[86:87]
    v_pk_add_f32 v[60:61], v[60:61], v[76:77]
    v_pk_add_f32 v[62:63], v[62:63], v[78:79]
    v_cvt_pk_bf16_f32 v92, v60, v61
    v_cvt_pk_bf16_f32 v93, v62, v63
    buffer_store_dwordx4 v[92:95], v57, s[44:47], s40 offen sc1
nopub_7:
    s_nop 3
    s_lshl_b32 s69, s34, 4
    s_add_u32 s69, s69, s35
    s_sub_u32 s69, s69, 16
    s_lshr_b32 s66, s69, 5
    s_bfe_u32 s67, s69, 0x30002
    s_and_b32 s68, s69, 3
    s_lshr_b32 s36, s69, 2
    s_lshl_b32 s36, s36, 20
    s_lshl_b32 s37, s68, 16
    s_add_u32 s36, s36, s37
    s_add_u32 s36, s36, 786432
    s_add_u32 s48, s18, s36
    s_addc_u32 s49, s19, 0
    s_and_b32 s49, s49, 0xffff
    s_mov_b32 s50, 0x10000
    s_mov_b32 s51, 0x20000
    v_add_u32 v200, 0, v10
    v_xor_b32 v200, v200, v11
    v_lshlrev_b32 v200, 4, v200
    v_lshl_add_u32 v196, v10, 8, v200
    v_add_u32 v200, 4, v10
    v_xor_b32 v200, v200, v11
    v_lshlrev_b32 v200, 4, v200
    v_lshl_add_u32 v197, v10, 8, v200
    v_add_u32 v200, 8, v10
    v_xor_b32 v200, v200, v11
    v_lshlrev_b32 v200, 4, v200
    v_lshl_add_u32 v198, v10, 8, v200
    v_add_u32 v200, 12, v10
    v_xor_b32 v200, v200, v11
    v_lshlrev_b32 v200, 4, v200
    v_lshl_add_u32 v199, v10, 8, v200
    s_lshl_b32 s43, s3, 13
    v_lshlrev_b32 v112, 11, v10
    v_lshl_add_u32 v112, v11, 4, v112
    s_lshl_b32 s36, s32, 13
    s_lshl_b32 s37, s3, 8
    s_add_u32 s36, s36, s37
    s_add_u32 s76, s36, 0x100000
    s_lshl_b32 s36, s67, 2
    s_lshr_b32 s37, s3, 1
    s_add_u32 s36, s36, s37
    s_lshl_b32 s36, s36, 13
    s_lshl_b32 s37, s66, 9
    s_add_u32 s36, s36, s37
    s_and_b32 s37, s3, 1
    s_lshl_b32 s37, s37, 8
    s_add_u32 s36, s36, s37
    s_add_u32 s79, s36, 0x140000
    v_lshlrev_b32 v113, 3, v11
    s_lshl_b32 s36, s3, 7
    s_add_u32 s36, s36, 0x26000
    v_add_u32 v113, s36, v113
    v_and_b32 v114, 3, v1
    v_lshlrev_b32 v114, 8, v114
    v_lshl_add_u32 v114, v10, 4, v114
    v_add_u32 v114, 0x26000, v114
    v_lshlrev_b32 v115, 8, v11
    v_lshl_add_u32 v115, v10, 3, v115
    s_lshl_b32 s36, s3, 5
    s_add_u32 s36, s36, 0x26400
    v_add_u32 v115, s36, v115
    v_lshlrev_b32 v120, 4, v1
    v_add_u32 v120, 0x26400, v120
    v_lshlrev_b32 v121, 15, v10
    v_lshl_add_u32 v121, v11, 4, v121
    s_lshl_b32 s36, s32, 10
    s_and_b32 s37, s33, 3
    s_lshl_b32 s37, s37, 8
    s_add_u32 s36, s36, s37
    s_add_u32 s78, s36, 0x180000
    v_xor_b32 v96, v10, v11
    v_lshlrev_b32 v96, 4, v96
    v_lshl_add_u32 v96, v11, 8, v96
    s_lshl_b32 s36, s3, 12
    s_add_u32 s36, s36, 98304
    v_add_u32 v96, s36, v96
    v_xor_b32 v116, 0, v96
    v_xor_b32 v117, 64, v96
    v_xor_b32 v118, 128, v96
    v_xor_b32 v119, 192, v96
    s_mul_i32 s36, s71, 0x9e3779b1
    v_and_b32 v60, 3, v1
    v_lshlrev_b32 v60, 3, v60
    v_lshrrev_b32 v60, v60, s36
    v_bfe_u32 v240, v60, 0, 1
    v_bfe_u32 v61, v60, 1, 1
    v_lshl_or_b32 v240, v61, 16, v240
    v_bfe_u32 v241, v60, 2, 1
    v_bfe_u32 v61, v60, 3, 1
    v_lshl_or_b32 v241, v61, 16, v241
    v_bfe_u32 v242, v60, 4, 1
    v_bfe_u32 v61, v60, 5, 1
    v_lshl_or_b32 v242, v61, 16, v242
    v_bfe_u32 v243, v60, 6, 1
    v_bfe_u32 v61, v60, 7, 1
    v_lshl_or_b32 v243, v61, 16, v243
    s_waitcnt vmcnt(0)
    s_mov_b32 s42, 0
    s_sleep 4
poll_8:
    buffer_load_dwordx4 v[160:163], v112, s[44:47], s76 offen sc1
    s_add_u32 s42, s42, 1
    s_waitcnt vmcnt(0)
    v_cmp_ne_u32 s[74:75], s70, v162
    s_cmp_eq_u64 s[74:75], 0
    s_cbranch_scc1 polld_9
    s_sleep 3
    s_cmp_lt_u32 s42, 0x20000
    s_cbranch_scc1 poll_8
polld_9:
    v_mfma_f32_16x16x32_bf16 v[24:27], v[12:15], v[160:163], 0
    s_nop 7
    v_cvt_pk_bf16_f32 v28, v24, v25
    v_cvt_pk_bf16_f32 v29, v26, v27
    s_mov_b64 exec, 0xffff
    ds_write_b64 v113, v[28:29]
    s_mov_b64 exec, -1
    s_waitcnt lgkmcnt(0)
    s_barrier
    ds_read_b128 v[24:27], v114 offset:0
    ds_read_b128 v[28:31], v114 offset:64
    ds_read_b128 v[32:35], v114 offset:128
    ds_read_b128 v[36:39], v114 offset:192
    ds_read_b128 v[96:99], v116
    ds_read_b128 v[100:103], v117
    ds_read_b128 v[104:107], v118
    ds_read_b128 v[108:111], v119
    v_cmp_gt_u32 vcc, 4, v11
    s_waitcnt lgkmcnt(0)
    v_mfma_f32_16x16x32_bf16 v[40:43], v[96:99], v[24:27], 0
    v_mfma_f32_16x16x32_bf16 v[40:43], v[100:103], v[28:31], v[40:43]
    v_mfma_f32_16x16x32_bf16 v[40:43], v[104:107], v[32:35], v[40:43]
    v_mfma_f32_16x16x32_bf16 v[40:43], v[108:111], v[36:39], v[40:43]
    s_nop 7
    v_cvt_pk_bf16_f32 v44, v40, v41
    v_cvt_pk_bf16_f32 v45, v42, v43
    s_and_saveexec_b64 s[64:65], vcc
    ds_write_b64 v115, v[44:45]
    s_mov_b64 exec, s[64:65]
    s_waitcnt lgkmcnt(0)
    s_barrier
    s_cmp_lg_u32 s3, 0
    s_cbranch_scc1 noq_10
    ds_read_b128 v[44:47], v120
    v_mov_b32 v48, 0x00010001
    s_waitcnt lgkmcnt(0)
    v_bfi_b32 v44, v48, v240, v44
    v_bfi_b32 v45, v48, v241, v45
    v_bfi_b32 v46, v48, v242, v46
    v_bfi_b32 v47, v48, v243, v47
    buffer_store_dwordx4 v[44:47], v121, s[44:47], s78 offen sc1
noq_10:
    s_nop 3
    s_barrier
    s_mov_b32 s42, 0
poll_11:
    buffer_load_dwordx4 v[28:31], v112, s[44:47], s79 offen sc1
    s_add_u32 s42, s42, 1
    s_waitcnt vmcnt(0)
    v_cmp_ne_u32 s[74:75], s70, v30
    s_cmp_eq_u64 s[74:75], 0
    s_cbranch_scc1 polld_12
    s_cmp_lt_u32 s42, 0x20000
    s_cbranch_scc1 poll_11
polld_12:
    v_mfma_f32_16x16x32_bf16 v[32:35], v[12:15], v[28:31], 0
    s_nop 7
    v_cvt_pk_bf16_f32 v36, v32, v33
    v_cvt_pk_bf16_f32 v37, v34, v35
    s_mov_b64 exec, 0xffff
    ds_write_b64 v113, v[36:37] offset:2048
    s_mov_b64 exec, -1
    s_waitcnt lgkmcnt(0)
    s_barrier
    s_lshr_b32 s36, s69, 2
    s_lshl_b32 s36, s36, 20
    s_lshl_b32 s37, s68, 16
    s_add_u32 s36, s36, s37
    s_add_u32 s36, s36, 786432
    s_add_u32 s52, s20, s36
    s_addc_u32 s53, s21, 0
    s_and_b32 s53, s53, 0xffff
    s_mov_b32 s54, 0x10000
    s_mov_b32 s55, 0x20000
    v_add_u32 v28, 0, v10
    v_lshlrev_b32 v28, 1, v28
    v_xor_b32 v28, v28, v11
    v_lshlrev_b32 v28, 4, v28
    v_lshl_add_u32 v24, v10, 8, v28
    v_add_u32 v28, 4, v10
    v_lshlrev_b32 v28, 1, v28
    v_xor_b32 v28, v28, v11
    v_lshlrev_b32 v28, 4, v28
    v_lshl_add_u32 v25, v10, 8, v28
    s_add_u32 s37, s43, 0
    s_mov_b32 m0, s37
    s_nop 0
    buffer_load_dwordx4 v196, s[48:51], s37 offen nt lds
    s_add_u32 s37, s43, 1024
    s_mov_b32 m0, s37
    s_nop 0
    buffer_load_dwordx4 v197, s[48:51], s37 offen nt lds
    s_add_u32 s37, s43, 2048
    s_mov_b32 m0, s37
    s_nop 0
    buffer_load_dwordx4 v198, s[48:51], s37 offen nt lds
    s_add_u32 s37, s43, 3072
    s_mov_b32 m0, s37
    s_nop 0
    buffer_load_dwordx4 v199, s[48:51], s37 offen nt lds
    s_add_u32 s37, s43, 4096
    s_mov_b32 m0, s37
    s_nop 0
    buffer_load_dwordx4 v196, s[48:51], s37 offen nt lds
    s_add_u32 s37, s43, 5120
    s_mov_b32 m0, s37
    s_nop 0
    buffer_load_dwordx4 v197, s[48:51], s37 offen nt lds
    s_add_u32 s37, s43, 6144
    s_mov_b32 m0, s37
    s_nop 0
    buffer_load_dwordx4 v198, s[48:51], s37 offen nt lds
    s_add_u32 s37, s43, 7168
    s_mov_b32 m0, s37
    s_nop 0
    buffer_load_dwordx4 v199, s[48:51], s37 offen nt lds
    s_add_u32 s37, s43, 0
    s_add_u32 s38, s37, 65536
    s_mov_b32 m0, s38
    s_nop 0
    buffer_load_dwordx4 v24, s[52:55], s37 offen nt lds
    s_add_u32 s37, s43, 1024
    s_add_u32 s38, s37, 65536
    s_mov_b32 m0, s38
    s_nop 0
    buffer_load_dwordx4 v25, s[52:55], s37 offen nt lds
    s_add_u32 s37, s43, 2048
    s_add_u32 s38, s37, 65536
    s_mov_b32 m0, s38
    s_nop 0
    buffer_load_dwordx4 v24, s[52:55], s37 offen nt lds
    s_add_u32 s37, s43, 3072
    s_add_u32 s38, s37, 65536
    s_mov_b32 m0, s38
    s_nop 0
    buffer_load_dwordx4 v25, s[52:55], s37 offen nt lds
    s_add_u32 s37, s43, 4096
    s_add_u32 s38, s37, 65536
    s_mov_b32 m0, s38
    s_nop 0
    buffer_load_dwordx4 v24, s[52:55], s37 offen nt lds
    s_add_u32 s37, s43, 5120
    s_add_u32 s38, s37, 65536
    s_mov_b32 m0, s38
    s_nop 0
    buffer_load_dwordx4 v25, s[52:55], s37 offen nt lds
    s_add_u32 s37, s43, 6144
    s_add_u32 s38, s37, 65536
    s_mov_b32 m0, s38
    s_nop 0
    buffer_load_dwordx4 v24, s[52:55], s37 offen nt lds
    s_add_u32 s37, s43, 7168
    s_add_u32 s38, s37, 65536
    s_mov_b32 m0, s38
    s_nop 0
    buffer_load_dwordx4 v25, s[52:55], s37 offen nt lds
    v_xor_b32 v28, v10, v11
    v_lshlrev_b32 v28, 4, v28
    v_lshl_add_u32 v28, v11, 8, v28
    s_lshl_b32 s36, s3, 13
    v_add_u32 v28, s36, v28
    v_xor_b32 v20, 0, v28
    v_xor_b32 v21, 64, v28
    v_xor_b32 v22, 128, v28
    v_xor_b32 v23, 192, v28
    v_and_b32 v86, 3, v1
    v_lshlrev_b32 v86, 5, v86
    v_add_u32 v86, 0x26c00, v86
    s_lshl_b32 s36, s3, 2
    v_add_u32 v87, s36, v86
    v_lshlrev_b32 v176, 4, v1
    v_add_u32 v176, 0x20000, v176
    s_lshl_b32 s36, s3, 10
    v_add_u32 v177, s36, v176
    v_bfe_u32 v60, v1, 2, 2
    v_and_b32 v61, 3, v1
    v_lshl_add_u32 v62, v10, 2, v60
    v_and_b32 v63, 7, v62
    v_lshlrev_b32 v63, 1, v63
    v_lshrrev_b32 v178, 1, v61
    s_lshl_b32 s36, s3, 1
    v_add_u32 v178, s36, v178
    v_xor_b32 v178, v178, v63
    v_lshlrev_b32 v178, 4, v178
    v_lshl_add_u32 v178, v62, 8, v178
    v_and_b32 v61, 1, v61
    v_lshl_add_u32 v178, v61, 3, v178
    v_add_u32 v178, 0x10000, v178
    v_lshlrev_b32 v179, 14, v11
    v_lshl_add_u32 v180, v10, 4, v179
    s_lshl_b32 s36, s67, 16
    s_lshl_b32 s37, s66, 12
    s_add_u32 s36, s36, s37
    s_lshl_b32 s37, s68, 10
    s_add_u32 s36, s36, s37
    s_add_u32 s76, s36, 0xa00000
    s_lshl_b32 s37, s3, 6
    s_add_u32 s77, s37, s76
    s_mov_b32 s78, 0x3e0293ee
    s_waitcnt vmcnt(8)
    ds_read_b128 v[28:31], v114 offset:2048
    ds_read_b128 v[32:35], v114 offset:2112
    ds_read_b128 v[36:39], v114 offset:2176
    ds_read_b128 v[40:43], v114 offset:2240
    ds_read_b128 v[44:47], v20 offset:0
    ds_read_b128 v[48:51], v21 offset:0
    ds_read_b128 v[52:55], v22 offset:0
    ds_read_b128 v[56:59], v23 offset:0
    ds_read_b128 v[60:63], v20 offset:4096
    ds_read_b128 v[64:67], v21 offset:4096
    ds_read_b128 v[68:71], v22 offset:4096
    ds_read_b128 v[72:75], v23 offset:4096
    s_waitcnt lgkmcnt(4)
    v_mfma_f32_16x16x32_bf16 v[76:79], v[44:47], v[28:31], 0
    v_mfma_f32_16x16x32_bf16 v[76:79], v[48:51], v[32:35], v[76:79]
    v_mfma_f32_16x16x32_bf16 v[76:79], v[52:55], v[36:39], v[76:79]
    v_mfma_f32_16x16x32_bf16 v[76:79], v[56:59], v[40:43], v[76:79]
    s_waitcnt lgkmcnt(0)
    v_mfma_f32_16x16x32_bf16 v[80:83], v[60:63], v[28:31], 0
    v_mfma_f32_16x16x32_bf16 v[80:83], v[64:67], v[32:35], v[80:83]
    v_mfma_f32_16x16x32_bf16 v[80:83], v[68:71], v[36:39], v[80:83]
    v_mfma_f32_16x16x32_bf16 v[80:83], v[72:75], v[40:43], v[80:83]
    s_nop 2
    v_max3_f32 v84, v76, v77, v78
    s_nop 3
    v_max3_f32 v84, v84, v79, v80
    v_max3_f32 v84, v84, v81, v82
    v_max_f32 v84, v84, v83
    v_mov_b32 v85, v84
    s_nop 1
    v_permlane16_swap_b32 v84, v85
    v_max_f32 v84, v84, v85
    v_mov_b32 v85, v84
    s_nop 1
    v_permlane32_swap_b32 v84, v85
    v_max_f32 v84, v84, v85
    ds_write_b32 v87, v84
    s_waitcnt lgkmcnt(0)
    s_barrier
    ds_read_b128 v[88:91], v86
    ds_read_b128 v[92:95], v86 offset:16
    s_waitcnt lgkmcnt(0)
    v_max3_f32 v84, v88, v89, v90
    v_max3_f32 v84, v84, v91, v92
    v_max3_f32 v84, v84, v93, v94
    v_max_f32 v84, v84, v95
    v_mul_f32 v84, s78, v84
    v_fma_f32 v76, v76, s78, -v84
    v_fma_f32 v77, v77, s78, -v84
    v_fma_f32 v78, v78, s78, -v84
    v_fma_f32 v79, v79, s78, -v84
    v_fma_f32 v80, v80, s78, -v84
    v_fma_f32 v81, v81, s78, -v84
    v_fma_f32 v82, v82, s78, -v84
    v_fma_f32 v83, v83, s78, -v84
    v_exp_f32 v76, v76
    v_exp_f32 v77, v77
    v_exp_f32 v78, v78
    v_exp_f32 v79, v79
    v_exp_f32 v80, v80
    v_exp_f32 v81, v81
    v_exp_f32 v82, v82
    v_exp_f32 v83, v83
    v_cvt_pk_bf16_f32 v92, v76, v77
    v_cvt_pk_bf16_f32 v93, v78, v79
    v_cvt_pk_bf16_f32 v94, v80, v81
    v_cvt_pk_bf16_f32 v95, v82, v83
    ds_write_b128 v177, v[92:95]
    v_add_f32 v88, v76, v77
    v_add_f32 v88, v88, v78
    v_add_f32 v88, v88, v79
    v_add_f32 v88, v88, v80
    v_add_f32 v88, v88, v81
    v_add_f32 v88, v88, v82
    v_add_f32 v88, v88, v83
    v_mov_b32 v85, v88
    s_nop 1
    v_permlane16_swap_b32 v88, v85
    v_add_f32 v88, v88, v85
    v_mov_b32 v85, v88
    s_nop 1
    v_permlane32_swap_b32 v88, v85
    v_add_f32 v88, v88, v85
    ds_write_b32 v87, v88 offset:128
    s_waitcnt vmcnt(0)
    s_waitcnt lgkmcnt(0)
    s_barrier
    ds_read_b128 v[28:31], v176 offset:0
    ds_read_b64_tr_b16 v[96:97], v178 offset:0
    ds_read_b64_tr_b16 v[98:99], v178 offset:4096
    ds_read_b128 v[32:35], v176 offset:1024
    ds_read_b64_tr_b16 v[100:101], v178 offset:8192
    ds_read_b64_tr_b16 v[102:103], v178 offset:12288
    ds_read_b128 v[36:39], v176 offset:2048
    ds_read_b64_tr_b16 v[104:105], v178 offset:16384
    ds_read_b64_tr_b16 v[106:107], v178 offset:20480
    ds_read_b128 v[40:43], v176 offset:3072
    ds_read_b64_tr_b16 v[108:109], v178 offset:24576
    ds_read_b64_tr_b16 v[110:111], v178 offset:28672
    ds_read_b128 v[44:47], v176 offset:4096
    ds_read_b64_tr_b16 v[112:113], v178 offset:32768
    ds_read_b64_tr_b16 v[114:115], v178 offset:36864
    ds_read_b128 v[48:51], v176 offset:5120
    ds_read_b64_tr_b16 v[116:117], v178 offset:40960
    ds_read_b64_tr_b16 v[118:119], v178 offset:45056
    ds_read_b128 v[52:55], v176 offset:6144
    ds_read_b64_tr_b16 v[120:121], v178 offset:49152
    ds_read_b64_tr_b16 v[122:123], v178 offset:53248
    ds_read_b128 v[56:59], v176 offset:7168
    ds_read_b64_tr_b16 v[124:125], v178 offset:57344
    ds_read_b64_tr_b16 v[126:127], v178 offset:61440
    ds_read_b128 v[88:91], v86 offset:128
    ds_read_b128 v[164:167], v86 offset:144
    s_waitcnt lgkmcnt(15)
    v_mfma_f32_16x16x32_bf16 v[160:163], v[96:99], v[28:31], 0
    s_waitcnt lgkmcnt(15)
    v_mfma_f32_16x16x32_bf16 v[160:163], v[100:103], v[32:35], v[160:163]
    s_waitcnt lgkmcnt(15)
    v_mfma_f32_16x16x32_bf16 v[160:163], v[104:107], v[36:39], v[160:163]
    s_waitcnt lgkmcnt(14)
    v_mfma_f32_16x16x32_bf16 v[160:163], v[108:111], v[40:43], v[160:163]
    s_waitcnt lgkmcnt(11)
    v_mfma_f32_16x16x32_bf16 v[160:163], v[112:115], v[44:47], v[160:163]
    s_waitcnt lgkmcnt(8)
    v_mfma_f32_16x16x32_bf16 v[160:163], v[116:119], v[48:51], v[160:163]
    s_waitcnt lgkmcnt(5)
    v_mfma_f32_16x16x32_bf16 v[160:163], v[120:123], v[52:55], v[160:163]
    s_waitcnt lgkmcnt(2)
    v_mfma_f32_16x16x32_bf16 v[160:163], v[124:127], v[56:59], v[160:163]
    s_waitcnt lgkmcnt(0)
    v_add_f32 v88, v88, v89
    v_add_f32 v90, v90, v91
    v_add_f32 v164, v164, v165
    v_add_f32 v166, v166, v167
    v_add_f32 v88, v88, v90
    v_add_f32 v164, v164, v166
    v_add_f32 v89, v88, v164
    v_mov_b32 v88, v84
    v_mov_b32 v90, v16
    v_mov_b32 v91, 0
    v_mov_b32 v170, v16
    v_mov_b32 v171, 0
    v_cmp_gt_u32 vcc, 4, v11
    v_cvt_pk_bf16_f32 v168, v160, v161
    v_cvt_pk_bf16_f32 v169, v162, v163
    s_and_saveexec_b64 s[64:65], vcc
    buffer_store_dwordx4 v[168:171], v180, s[44:47], s77 offen sc1
    s_cmp_lg_u32 s3, 0
    s_cbranch_scc1 nostatB_13
    s_mov_b64 exec, 0xf
    buffer_store_dwordx4 v[88:91], v179, s[44:47], s76 offen offset:512 sc1
nostatB_13:
    s_mov_b64 exec, -1
    s_barrier
    s_mov_b32 s52, s24
    s_and_b32 s53, s25, 0xffff
    s_mov_b32 s54, 0x400000
    s_mov_b32 s55, 0x20000
    v_lshlrev_b32 v245, 14, v10
    v_lshl_add_u32 v245, v11, 4, v245
    s_lshl_b32 s36, s72, 6
    s_lshl_b32 s37, s3, 1
    s_add_u32 s36, s36, s37
    s_lshl_b32 s36, s36, 10
    s_lshl_b32 s38, s73, 9
    s_add_u32 s36, s36, s38
    buffer_load_dwordx4 v[224:227], v245, s[52:55], s36 offen offset:0 nt
    buffer_load_dwordx4 v[228:231], v245, s[52:55], s36 offen offset:1024 nt
    buffer_load_dwordx4 v[232:235], v245, s[52:55], s36 offen offset:256 nt
    buffer_load_dwordx4 v[236:239], v245, s[52:55], s36 offen offset:1280 nt
    s_branch doneB_3
doneB_3:
    v_lshrrev_b32 v96, 3, v11
    v_lshlrev_b32 v96, 7, v96
    v_lshl_add_u32 v96, v10, 5, v96
    s_lshl_b32 s36, s3, 2
    v_add_u32 v96, s36, v96
    v_lshrrev_b32 v97, 5, v1
    v_mul_u32_u24 v97, 768, v97
    v_lshl_add_u32 v97, v11, 4, v97
    v_and_b32 v98, 1, v10
    v_mul_u32_u24 v98, 384, v98
    v_add_u32 v97, v97, v98
    s_mul_i32 s36, s3, 3072
    s_add_u32 s36, s36, 0x0
    v_add_u32 v97, s36, v97
    v_bfe_u32 v95, v0, 5, 2
    v_mul_u32_u24 v95, 768, v95
    v_and_b32 v98, 1, v0
    v_mul_u32_u24 v98, 384, v98
    v_add_u32 v95, v95, v98
    v_bfe_u32 v98, v0, 1, 4
    v_lshl_add_u32 v95, v98, 4, v95
    v_and_b32 v98, 127, v0
    v_lshlrev_b32 v98, 4, v98
    s_and_b32 s39, s3, 3
    v_lshlrev_b32 v112, 3, v11
    s_lshl_b32 s36, s39, 7
    v_add_u32 v112, s36, v112
    s_lshl_b32 s36, s32, 2
    s_add_u32 s36, s36, s39
    s_lshl_b32 s36, s36, 12
    s_add_u32 s60, s36, 0xa00000
    s_and_b32 s37, s72, 1
    s_lshl_b32 s37, s37, 8
    s_add_u32 s61, s60, s37
    v_lshlrev_b32 v113, 10, v10
    v_lshl_add_u32 v114, v11, 4, v113
    s_barrier
    s_cmp_ge_u32 s3, 4
    s_cbranch_scc1 bother_14
    s_mov_b32 s42, 0
    s_sleep 8
poll_16:
    buffer_load_dwordx4 v[32:35], v114, s[44:47], s61 offen sc1
    buffer_load_dwordx4 v[36:39], v113, s[44:47], s60 offen offset:512 sc1
    s_add_u32 s42, s42, 1
    s_waitcnt vmcnt(0)
    v_cmp_ne_u32 s[74:75], s70, v34
    v_cmp_ne_u32 vcc, s70, v38
    s_or_b64 s[74:75], s[74:75], vcc
    s_cmp_eq_u64 s[74:75], 0
    s_cbranch_scc1 polld_17
    s_sleep 6
    s_cmp_lt_u32 s42, 0x20000
    s_cbranch_scc1 poll_16
polld_17:
    v_mov_b32 v80, v36
    v_mov_b32 v81, v80
    s_nop 1
    v_permlane16_swap_b32 v80, v81
    v_max_f32 v80, v80, v81
    v_mov_b32 v81, v80
    s_nop 1
    v_permlane32_swap_b32 v80, v81
    v_max_f32 v80, v80, v81
    v_sub_f32 v36, v36, v80
    v_exp_f32 v36, v36
    s_nop 0
    v_mul_f32 v82, v36, v37
    v_mov_b32 v81, v82
    s_nop 1
    v_permlane16_swap_b32 v82, v81
    v_add_f32 v82, v82, v81
    v_mov_b32 v81, v82
    s_nop 1
    v_permlane32_swap_b32 v82, v81
    v_add_f32 v82, v82, v81
    v_rcp_f32 v82, v82
    s_nop 0
    v_mul_f32 v36, v36, v82
    v_cvt_pk_bf16_f32 v84, v36, v36
    v_perm_b32 v88, v84, v84, v2
    v_perm_b32 v89, v84, v84, v4
    v_perm_b32 v90, v84, v84, v6
    v_perm_b32 v91, v84, v84, v8
    s_nop 1
    v_mfma_f32_16x16x32_bf16 v[104:107], v[88:91], v[32:35], 0
    s_nop 7
    v_cvt_pk_bf16_f32 v100, v104, v105
    v_cvt_pk_bf16_f32 v101, v106, v107
    s_mov_b64 exec, 0xffff
    ds_write_b64 v112, v[100:101] offset:1024
    s_mov_b64 exec, -1
    s_branch bdone_15
bother_14:
    s_nop 0
    s_lshl_b32 s36, s34, 2
    s_and_b32 s37, s33, 3
    s_add_u32 s36, s36, s37
    s_lshr_b32 s67, s36, 3
    s_bfe_u32 s68, s36, 0x20001
    s_and_b32 s69, s36, 1
    v_lshlrev_b32 v18, 13, v10
    v_lshl_add_u32 v18, v11, 4, v18
    s_lshl_b32 s36, s67, 11
    s_lshl_b32 s37, s68, 9
    s_add_u32 s36, s36, s37
    s_lshl_b32 s37, s69, 8
    s_add_u32 s36, s36, s37
    s_add_u32 s78, s36, 0xc80000
    s_mov_b32 s48, s26
    s_and_b32 s49, s27, 0xffff
    s_mov_b32 s50, 0x2000
    s_mov_b32 s51, 0x20000
    s_lshl_b32 s36, s68, 11
    s_lshl_b32 s37, s67, 8
    s_add_u32 s36, s36, s37
    s_lshl_b32 s37, s69, 7
    s_add_u32 s36, s36, s37
    s_add_u32 s79, s36, 1024
    v_lshlrev_b32 v19, 3, v11
bdone_15:
    s_nop 4
    s_lshl_b32 s41, s72, 2
    s_lshl_b32 s36, s73, 1
    s_add_u32 s41, s41, s36
    s_lshl_b32 s41, s41, 11
    s_add_u32 s41, s41, 0xc80000
    s_waitcnt vmcnt(0) lgkmcnt(0)
    s_barrier
    ds_read_b32 v100, v96 offset:1024
    ds_read_b32 v101, v96 offset:1280
    s_waitcnt lgkmcnt(0)
    v_perm_b32 v152, v100, v100, v2
    v_perm_b32 v153, v100, v100, v4
    v_perm_b32 v154, v100, v100, v6
    v_perm_b32 v155, v100, v100, v8
    v_perm_b32 v156, v101, v101, v2
    v_perm_b32 v157, v101, v101, v4
    v_perm_b32 v158, v101, v101, v6
    v_perm_b32 v159, v101, v101, v8
    v_perm_b32 v160, v100, v100, v3
    v_perm_b32 v161, v100, v100, v5
    v_perm_b32 v162, v100, v100, v7
    v_perm_b32 v163, v100, v100, v9
    v_perm_b32 v164, v101, v101, v3
    v_perm_b32 v165, v101, v101, v5
    v_perm_b32 v166, v101, v101, v7
    v_perm_b32 v167, v101, v101, v9
    v_mfma_f32_16x16x32_bf16 v[104:107], v[152:155], v[224:227], 0
    v_mfma_f32_16x16x32_bf16 v[108:111], v[156:159], v[224:227], 0
    v_mfma_f32_16x16x32_bf16 v[112:115], v[152:155], v[232:235], 0
    v_mfma_f32_16x16x32_bf16 v[116:119], v[156:159], v[232:235], 0
    v_mfma_f32_16x16x32_bf16 v[104:107], v[160:163], v[228:231], v[104:107]
    v_mfma_f32_16x16x32_bf16 v[108:111], v[164:167], v[228:231], v[108:111]
    v_mfma_f32_16x16x32_bf16 v[112:115], v[160:163], v[236:239], v[112:115]
    v_mfma_f32_16x16x32_bf16 v[116:119], v[164:167], v[236:239], v[116:119]
    s_nop 4
    ds_write_b128 v97, v[104:107] offset:2048
    ds_write_b128 v97, v[108:111] offset:3584
    ds_write_b128 v97, v[112:115] offset:26624
    ds_write_b128 v97, v[116:119] offset:28160
    s_waitcnt lgkmcnt(0)
    s_barrier
    s_cmp_ge_u32 s3, 4
    s_cbranch_scc1 fin_18
    s_cmp_ge_u32 s3, 2
    s_cbranch_scc1 pub2_20
    ds_read_b128 v[48:51], v95 offset:2048
    ds_read_b128 v[52:55], v95 offset:5120
    ds_read_b128 v[56:59], v95 offset:8192
    ds_read_b128 v[60:63], v95 offset:11264
    ds_read_b128 v[64:67], v95 offset:14336
    ds_read_b128 v[68:71], v95 offset:17408
    ds_read_b128 v[72:75], v95 offset:20480
    ds_read_b128 v[76:79], v95 offset:23552
    v_mov_b32 v82, v16
    v_mov_b32 v83, 0
    s_waitcnt lgkmcnt(4)
    v_pk_add_f32 v[48:49], v[48:49], v[52:53]
    v_pk_add_f32 v[50:51], v[50:51], v[54:55]
    v_pk_add_f32 v[56:57], v[56:57], v[60:61]
    v_pk_add_f32 v[58:59], v[58:59], v[62:63]
    v_pk_add_f32 v[48:49], v[48:49], v[56:57]
    v_pk_add_f32 v[50:51], v[50:51], v[58:59]
    s_waitcnt lgkmcnt(0)
    v_pk_add_f32 v[64:65], v[64:65], v[68:69]
    v_pk_add_f32 v[66:67], v[66:67], v[70:71]
    v_pk_add_f32 v[72:73], v[72:73], v[76:77]
    v_pk_add_f32 v[74:75], v[74:75], v[78:79]
    v_pk_add_f32 v[64:65], v[64:65], v[72:73]
    v_pk_add_f32 v[66:67], v[66:67], v[74:75]
    v_pk_add_f32 v[48:49], v[48:49], v[64:65]
    v_pk_add_f32 v[50:51], v[50:51], v[66:67]
    v_cvt_pk_bf16_f32 v80, v48, v49
    v_cvt_pk_bf16_f32 v81, v50, v51
    buffer_store_dwordx4 v[80:83], v98, s[44:47], s41 offen sc1
    s_branch tail_end_19
pub2_20:
    s_nop 2
    s_add_u32 s36, s41, 2048
    ds_read_b128 v[48:51], v95 offset:26624
    ds_read_b128 v[52:55], v95 offset:29696
    ds_read_b128 v[56:59], v95 offset:32768
    ds_read_b128 v[60:63], v95 offset:35840
    ds_read_b128 v[64:67], v95 offset:38912
    ds_read_b128 v[68:71], v95 offset:41984
    ds_read_b128 v[72:75], v95 offset:45056
    ds_read_b128 v[76:79], v95 offset:48128
    v_mov_b32 v82, v16
    v_mov_b32 v83, 0
    s_waitcnt lgkmcnt(4)
    v_pk_add_f32 v[48:49], v[48:49], v[52:53]
    v_pk_add_f32 v[50:51], v[50:51], v[54:55]
    v_pk_add_f32 v[56:57], v[56:57], v[60:61]
    v_pk_add_f32 v[58:59], v[58:59], v[62:63]
    v_pk_add_f32 v[48:49], v[48:49], v[56:57]
    v_pk_add_f32 v[50:51], v[50:51], v[58:59]
    s_waitcnt lgkmcnt(0)
    v_pk_add_f32 v[64:65], v[64:65], v[68:69]
    v_pk_add_f32 v[66:67], v[66:67], v[70:71]
    v_pk_add_f32 v[72:73], v[72:73], v[76:77]
    v_pk_add_f32 v[74:75], v[74:75], v[78:79]
    v_pk_add_f32 v[64:65], v[64:65], v[72:73]
    v_pk_add_f32 v[66:67], v[66:67], v[74:75]
    v_pk_add_f32 v[48:49], v[48:49], v[64:65]
    v_pk_add_f32 v[50:51], v[50:51], v[66:67]
    v_cvt_pk_bf16_f32 v80, v48, v49
    v_cvt_pk_bf16_f32 v81, v50, v51
    buffer_store_dwordx4 v[80:83], v98, s[44:47], s36 offen sc1
    s_branch tail_end_19
fin_18:
    s_nop 2
    s_cmp_lg_u32 s3, 4
    s_cbranch_scc1 tail_end_19
    s_and_b32 s36, s35, 3
    s_cmp_lg_u32 s36, 0
    s_cbranch_scc1 tail_end_19
    s_mov_b32 s42, 0
    s_sleep 10
    s_add_u32 s37, s78, 0
    buffer_load_dwordx4 v[32:35], v18, s[44:47], s37 offen sc1
    s_add_u32 s37, s78, 32768
    buffer_load_dwordx4 v[36:39], v18, s[44:47], s37 offen sc1
    s_add_u32 s37, s78, 65536
    buffer_load_dwordx4 v[40:43], v18, s[44:47], s37 offen sc1
    s_add_u32 s37, s78, 98304
    buffer_load_dwordx4 v[44:47], v18, s[44:47], s37 offen sc1
    s_add_u32 s37, s78, 131072
    buffer_load_dwordx4 v[48:51], v18, s[44:47], s37 offen sc1
    s_add_u32 s37, s78, 163840
    buffer_load_dwordx4 v[52:55], v18, s[44:47], s37 offen sc1
    s_add_u32 s37, s78, 196608
    buffer_load_dwordx4 v[56:59], v18, s[44:47], s37 offen sc1
    s_add_u32 s37, s78, 229376
    buffer_load_dwordx4 v[60:63], v18, s[44:47], s37 offen sc1
    s_add_u32 s37, s78, 262144
    buffer_load_dwordx4 v[64:67], v18, s[44:47], s37 offen sc1
    s_add_u32 s37, s78, 294912
    buffer_load_dwordx4 v[68:71], v18, s[44:47], s37 offen sc1
    s_add_u32 s37, s78, 327680
    buffer_load_dwordx4 v[72:75], v18, s[44:47], s37 offen sc1
    s_add_u32 s37, s78, 360448
    buffer_load_dwordx4 v[76:79], v18, s[44:47], s37 offen sc1
    s_add_u32 s37, s78, 393216
    buffer_load_dwordx4 v[80:83], v18, s[44:47], s37 offen sc1
    s_add_u32 s37, s78, 425984
    buffer_load_dwordx4 v[84:87], v18, s[44:47], s37 offen sc1
    s_add_u32 s37, s78, 458752
    buffer_load_dwordx4 v[88:91], v18, s[44:47], s37 offen sc1
    s_add_u32 s37, s78, 491520
    buffer_load_dwordx4 v[92:95], v18, s[44:47], s37 offen sc1
pm_21:
    s_waitcnt vmcnt(0)
    v_xor_b32 v96, v34, v16
    v_bitop3_b32 v96, v38, v16, v96 bitop3:0xbe
    v_bitop3_b32 v96, v42, v16, v96 bitop3:0xbe
    v_bitop3_b32 v96, v46, v16, v96 bitop3:0xbe
    v_bitop3_b32 v96, v50, v16, v96 bitop3:0xbe
    v_bitop3_b32 v96, v54, v16, v96 bitop3:0xbe
    v_bitop3_b32 v96, v58, v16, v96 bitop3:0xbe
    v_bitop3_b32 v96, v62, v16, v96 bitop3:0xbe
    v_bitop3_b32 v96, v66, v16, v96 bitop3:0xbe
    v_bitop3_b32 v96, v70, v16, v96 bitop3:0xbe
    v_bitop3_b32 v96, v74, v16, v96 bitop3:0xbe
    v_bitop3_b32 v96, v78, v16, v96 bitop3:0xbe
    v_bitop3_b32 v96, v82, v16, v96 bitop3:0xbe
    v_bitop3_b32 v96, v86, v16, v96 bitop3:0xbe
    v_bitop3_b32 v96, v90, v16, v96 bitop3:0xbe
    v_bitop3_b32 v96, v94, v16, v96 bitop3:0xbe
    v_cmp_ne_u32 vcc, 0, v96
    s_cbranch_vccz pmd_22
    s_mov_b32 s74, 0
    v_cmp_ne_u32 vcc, s70, v34
    s_cbranch_vccz pms_23
    s_add_u32 s37, s78, 0
    buffer_load_dwordx4 v[32:35], v18, s[44:47], s37 offen sc1
    s_mov_b32 s74, 1
pms_23:
    v_cmp_ne_u32 vcc, s70, v38
    s_cbranch_vccz pms_24
    s_add_u32 s37, s78, 32768
    buffer_load_dwordx4 v[36:39], v18, s[44:47], s37 offen sc1
    s_mov_b32 s74, 1
pms_24:
    v_cmp_ne_u32 vcc, s70, v42
    s_cbranch_vccz pms_25
    s_add_u32 s37, s78, 65536
    buffer_load_dwordx4 v[40:43], v18, s[44:47], s37 offen sc1
    s_mov_b32 s74, 1
pms_25:
    v_cmp_ne_u32 vcc, s70, v46
    s_cbranch_vccz pms_26
    s_add_u32 s37, s78, 98304
    buffer_load_dwordx4 v[44:47], v18, s[44:47], s37 offen sc1
    s_mov_b32 s74, 1
pms_26:
    v_cmp_ne_u32 vcc, s70, v50
    s_cbranch_vccz pms_27
    s_add_u32 s37, s78, 131072
    buffer_load_dwordx4 v[48:51], v18, s[44:47], s37 offen sc1
    s_mov_b32 s74, 1
pms_27:
    v_cmp_ne_u32 vcc, s70, v54
    s_cbranch_vccz pms_28
    s_add_u32 s37, s78, 163840
    buffer_load_dwordx4 v[52:55], v18, s[44:47], s37 offen sc1
    s_mov_b32 s74, 1
pms_28:
    v_cmp_ne_u32 vcc, s70, v58
    s_cbranch_vccz pms_29
    s_add_u32 s37, s78, 196608
    buffer_load_dwordx4 v[56:59], v18, s[44:47], s37 offen sc1
    s_mov_b32 s74, 1
pms_29:
    v_cmp_ne_u32 vcc, s70, v62
    s_cbranch_vccz pms_30
    s_add_u32 s37, s78, 229376
    buffer_load_dwordx4 v[60:63], v18, s[44:47], s37 offen sc1
    s_mov_b32 s74, 1
pms_30:
    v_cmp_ne_u32 vcc, s70, v66
    s_cbranch_vccz pms_31
    s_add_u32 s37, s78, 262144
    buffer_load_dwordx4 v[64:67], v18, s[44:47], s37 offen sc1
    s_mov_b32 s74, 1
pms_31:
    v_cmp_ne_u32 vcc, s70, v70
    s_cbranch_vccz pms_32
    s_add_u32 s37, s78, 294912
    buffer_load_dwordx4 v[68:71], v18, s[44:47], s37 offen sc1
    s_mov_b32 s74, 1
pms_32:
    v_cmp_ne_u32 vcc, s70, v74
    s_cbranch_vccz pms_33
    s_add_u32 s37, s78, 327680
    buffer_load_dwordx4 v[72:75], v18, s[44:47], s37 offen sc1
    s_mov_b32 s74, 1
pms_33:
    v_cmp_ne_u32 vcc, s70, v78
    s_cbranch_vccz pms_34
    s_add_u32 s37, s78, 360448
    buffer_load_dwordx4 v[76:79], v18, s[44:47], s37 offen sc1
    s_mov_b32 s74, 1
pms_34:
    v_cmp_ne_u32 vcc, s70, v82
    s_cbranch_vccz pms_35
    s_add_u32 s37, s78, 393216
    buffer_load_dwordx4 v[80:83], v18, s[44:47], s37 offen sc1
    s_mov_b32 s74, 1
pms_35:
    v_cmp_ne_u32 vcc, s70, v86
    s_cbranch_vccz pms_36
    s_add_u32 s37, s78, 425984
    buffer_load_dwordx4 v[84:87], v18, s[44:47], s37 offen sc1
    s_mov_b32 s74, 1
pms_36:
    v_cmp_ne_u32 vcc, s70, v90
    s_cbranch_vccz pms_37
    s_add_u32 s37, s78, 458752
    buffer_load_dwordx4 v[88:91], v18, s[44:47], s37 offen sc1
    s_mov_b32 s74, 1
pms_37:
    v_cmp_ne_u32 vcc, s70, v94
    s_cbranch_vccz pms_38
    s_add_u32 s37, s78, 491520
    buffer_load_dwordx4 v[92:95], v18, s[44:47], s37 offen sc1
    s_mov_b32 s74, 1
pms_38:
    s_cmp_eq_u32 s74, 0
    s_cbranch_scc1 pmd_22
    s_add_u32 s42, s42, 1
    s_sleep 2
    s_cmp_lt_u32 s42, 0x20000
    s_cbranch_scc1 pm_21
    s_waitcnt vmcnt(0)
pmd_22:
    v_mfma_f32_16x16x32_bf16 v[100:103], v[12:15], v[32:35], 0
    v_mfma_f32_16x16x32_bf16 v[104:107], v[12:15], v[36:39], 0
    v_mfma_f32_16x16x32_bf16 v[108:111], v[12:15], v[40:43], 0
    v_mfma_f32_16x16x32_bf16 v[112:115], v[12:15], v[44:47], 0
    v_mfma_f32_16x16x32_bf16 v[100:103], v[12:15], v[48:51], v[100:103]
    v_mfma_f32_16x16x32_bf16 v[104:107], v[12:15], v[52:55], v[104:107]
    v_mfma_f32_16x16x32_bf16 v[108:111], v[12:15], v[56:59], v[108:111]
    v_mfma_f32_16x16x32_bf16 v[112:115], v[12:15], v[60:63], v[112:115]
    v_mfma_f32_16x16x32_bf16 v[100:103], v[12:15], v[64:67], v[100:103]
    v_mfma_f32_16x16x32_bf16 v[104:107], v[12:15], v[68:71], v[104:107]
    v_mfma_f32_16x16x32_bf16 v[108:111], v[12:15], v[72:75], v[108:111]
    v_mfma_f32_16x16x32_bf16 v[112:115], v[12:15], v[76:79], v[112:115]
    v_mfma_f32_16x16x32_bf16 v[100:103], v[12:15], v[80:83], v[100:103]
    v_mfma_f32_16x16x32_bf16 v[104:107], v[12:15], v[84:87], v[104:107]
    v_mfma_f32_16x16x32_bf16 v[108:111], v[12:15], v[88:91], v[108:111]
    v_mfma_f32_16x16x32_bf16 v[112:115], v[12:15], v[92:95], v[112:115]
    s_nop 5
    v_pk_add_f32 v[100:101], v[100:101], v[104:105]
    s_nop 0
    v_pk_add_f32 v[108:109], v[108:109], v[112:113]
    v_pk_add_f32 v[102:103], v[102:103], v[106:107]
    v_pk_add_f32 v[110:111], v[110:111], v[114:115]
    v_pk_add_f32 v[100:101], v[100:101], v[108:109]
    v_pk_add_f32 v[102:103], v[102:103], v[110:111]
    v_cvt_pk_bf16_f32 v108, v100, v101
    v_cvt_pk_bf16_f32 v109, v102, v103
    s_mov_b64 exec, 0xffff
    buffer_store_dwordx2 v[108:109], v19, s[48:51], s79 offen
tail_end_19:
    s_nop 2
    s_mov_b64 exec, -1
    s_branch allend_4
roleA1_6:
    s_load_dword s71, s[30:31], 0
    s_mov_b32 s44, s30
    s_and_b32 s45, s31, 0xffff
    s_mov_b32 s46, 0x10000000
    s_mov_b32 s47, 0x20000
    s_lshl_b32 s72, s32, 1
    s_bfe_u32 s36, s33, 0x10001
    s_add_u32 s72, s72, s36
    s_and_b32 s73, s33, 1
    v_bfe_u32 v44, v1, 1, 2
    v_and_b32 v45, 1, v1
    v_lshlrev_b32 v45, 4, v45
    v_cmp_eq_u32 s[64:65], 0, v44
    v_cmp_eq_u32 s[74:75], 1, v44
    v_cmp_eq_u32 s[76:77], 2, v44
    v_cmp_eq_u32 s[78:79], 3, v44
    v_mov_b32 v46, 0x0c0c0100
    v_alignbit_b32 v46, v46, v46, v45
    v_mov_b32 v47, 0x0c0c0302
    v_alignbit_b32 v47, v47, v47, v45
    v_mov_b32 v44, 0x0c0c0c0c
    v_cndmask_b32 v2, v44, v46, s[64:65]
    v_cndmask_b32 v3, v44, v47, s[64:65]
    v_cndmask_b32 v4, v44, v46, s[74:75]
    v_cndmask_b32 v5, v44, v47, s[74:75]
    v_cndmask_b32 v6, v44, v46, s[76:77]
    v_cndmask_b32 v7, v44, v47, s[76:77]
    v_cndmask_b32 v8, v44, v46, s[78:79]
    v_cndmask_b32 v9, v44, v47, s[78:79]
    v_mov_b32 v44, 0x3f803f80
    v_perm_b32 v12, v44, v44, v2
    v_perm_b32 v13, v44, v44, v4
    v_perm_b32 v14, v44, v44, v6
    v_perm_b32 v15, v44, v44, v8
    s_waitcnt lgkmcnt(0)
    s_add_u32 s71, s71, 1
    s_and_b32 s70, s71, 0x3fff
    s_bfe_u32 s36, s71, 0xe000e
    s_lshl_b32 s36, s36, 16
    s_or_b32 s70, s70, s36
    v_mov_b32 v16, s70
    v_lshlrev_b32 v18, 4, v1
    s_lshl_b32 s36, s66, 15
    s_lshl_b32 s37, s3, 12
    s_add_u32 s36, s36, s37
    s_add_u32 s76, s36, 0x180000
    s_add_u32 s77, s37, 0x20000
    s_and_b32 s38, s3, 3
    s_lshl_b32 s38, s38, 4
    s_or_b32 s40, s38, 0
    v_xor_b32 v169, s40, v18
    s_or_b32 s40, s38, 64
    v_xor_b32 v170, s40, v18
    s_or_b32 s40, s38, 128
    v_xor_b32 v171, s40, v18
    s_or_b32 s40, s38, 192
    v_xor_b32 v172, s40, v18
    v_lshlrev_b32 v168, 4, v1
    v_add_u32 v173, s77, v168
    v_and_b32 v112, 31, v1
    v_lshrrev_b32 v113, 5, v1
    v_and_b32 v114, 3, v112
    v_lshlrev_b32 v114, 2, v114
    v_bfe_u32 v115, v112, 2, 2
    v_or_b32 v114, v114, v115
    v_xor_b32 v114, v114, v113
    v_lshlrev_b32 v114, 4, v114
    v_lshl_add_u32 v114, v112, 10, v114
    s_and_b32 s36, s3, 3
    s_lshl_b32 s36, s36, 15
    v_xor_b32 v136, 0, v114
    v_add_u32 v128, s36, v136
    v_add_u32 v136, 0x20000, v136
    v_xor_b32 v137, 32, v114
    v_add_u32 v129, s36, v137
    v_add_u32 v137, 0x20000, v137
    v_xor_b32 v138, 64, v114
    v_add_u32 v130, s36, v138
    v_add_u32 v138, 0x20000, v138
    v_xor_b32 v139, 96, v114
    v_add_u32 v131, s36, v139
    v_add_u32 v139, 0x20000, v139
    v_xor_b32 v140, 128, v114
    v_add_u32 v132, s36, v140
    v_add_u32 v140, 0x20000, v140
    v_xor_b32 v141, 160, v114
    v_add_u32 v133, s36, v141
    v_add_u32 v141, 0x20000, v141
    v_xor_b32 v142, 192, v114
    v_add_u32 v134, s36, v142
    v_add_u32 v142, 0x20000, v142
    v_xor_b32 v143, 224, v114
    v_add_u32 v135, s36, v143
    v_add_u32 v143, 0x20000, v143
    v_bfe_u32 v117, v1, 2, 2
    v_and_b32 v118, 3, v1
    v_lshrrev_b32 v119, 5, v1
    v_bfe_u32 v124, v1, 4, 1
    v_lshl_add_u32 v125, v119, 2, v117
    v_lshlrev_b32 v125, 10, v125
    v_lshlrev_b32 v124, 1, v124
    v_lshrrev_b32 v126, 1, v118
    v_add_u32 v124, v124, v126
    v_xor_b32 v124, v124, v119
    v_lshl_add_u32 v124, v117, 2, v124
    s_and_b32 s36, s3, 1
    s_lshl_b32 s36, s36, 3
    v_xor_b32 v124, s36, v124
    v_lshl_add_u32 v125, v124, 4, v125
    v_and_b32 v118, 1, v118
    v_lshl_add_u32 v125, v118, 3, v125
    s_lshr_b32 s36, s3, 1
    s_lshl_b32 s36, s36, 8
    v_add_u32 v125, s36, v125
    v_xor_b32 v144, 0, v125
    v_add_u32 v148, 0x10000, v144
    v_xor_b32 v145, 32, v125
    v_add_u32 v149, 0x10000, v145
    v_xor_b32 v146, 64, v125
    v_add_u32 v150, 0x10000, v146
    v_xor_b32 v147, 96, v125
    v_add_u32 v151, 0x10000, v147
    v_and_b32 v152, 31, v1
    v_lshlrev_b32 v152, 2, v152
    v_add_u32 v152, 0x20000, v152
    s_and_b32 s37, s3, 3
    s_lshl_b32 s36, s37, 7
    v_add_u32 v153, s36, v152
    v_add_u32 v154, 0x20400, v18
    s_lshl_b32 s36, s37, 11
    v_add_u32 v155, s36, v154
    v_and_b32 v157, 31, v1
    v_mul_u32_u24 v157, 1040, v157
    v_lshrrev_b32 v118, 5, v1
    v_lshl_add_u32 v156, v118, 3, v157
    s_lshl_b32 s36, s3, 7
    v_add_u32 v156, s36, v156
    s_mul_i32 s36, s3, 1040
    v_add_u32 v160, s36, v18
    v_lshlrev_b32 v161, 4, v0
    v_and_b32 v162, 31, v1
    v_lshlrev_b32 v162, 4, v162
    s_mul_i32 s36, s71, 0x9e3779b1
    v_and_b32 v60, 3, v1
    v_lshlrev_b32 v60, 3, v60
    v_lshrrev_b32 v60, v60, s36
    v_bfe_u32 v240, v60, 0, 1
    v_bfe_u32 v61, v60, 1, 1
    v_lshl_or_b32 v240, v61, 16, v240
    v_bfe_u32 v241, v60, 2, 1
    v_bfe_u32 v61, v60, 3, 1
    v_lshl_or_b32 v241, v61, 16, v241
    v_bfe_u32 v242, v60, 4, 1
    v_bfe_u32 v61, v60, 5, 1
    v_lshl_or_b32 v242, v61, 16, v242
    v_bfe_u32 v243, v60, 6, 1
    v_bfe_u32 v61, v60, 7, 1
    v_lshl_or_b32 v243, v61, 16, v243
    s_mul_i32 s36, s71, 0x9e3779b1
    v_xor_b32 v60, s3, v1
    v_and_b32 v60, 3, v60
    v_lshlrev_b32 v60, 3, v60
    v_lshrrev_b32 v60, v60, s36
    v_bfe_u32 v164, v60, 0, 1
    v_bfe_u32 v61, v60, 1, 1
    v_lshl_or_b32 v164, v61, 16, v164
    v_bfe_u32 v165, v60, 2, 1
    v_bfe_u32 v61, v60, 3, 1
    v_lshl_or_b32 v165, v61, 16, v165
    v_bfe_u32 v166, v60, 4, 1
    v_bfe_u32 v61, v60, 5, 1
    v_lshl_or_b32 v166, v61, 16, v166
    v_bfe_u32 v167, v60, 6, 1
    v_bfe_u32 v61, v60, 7, 1
    v_lshl_or_b32 v167, v61, 16, v167
    v_mov_b32 v163, 0x00010001
    v_lshrrev_b32 v19, 5, v1
    v_mul_u32_u24 v19, 768, v19
    v_lshl_add_u32 v19, v11, 4, v19
    v_and_b32 v56, 1, v10
    v_mul_u32_u24 v56, 384, v56
    v_add_u32 v19, v19, v56
    s_mul_i32 s36, s3, 3072
    s_add_u32 s36, s36, 0x20000
    v_add_u32 v19, s36, v19
    v_lshlrev_b32 v57, 4, v0
    v_bfe_u32 v58, v0, 5, 2
    v_mul_u32_u24 v58, 768, v58
    v_and_b32 v56, 1, v0
    v_mul_u32_u24 v56, 384, v56
    v_add_u32 v58, v58, v56
    v_bfe_u32 v56, v0, 1, 4
    v_lshl_add_u32 v58, v56, 4, v58
    v_add_u32 v58, 0x20000, v58
    s_lshl_b32 s40, s32, 2
    s_and_b32 s37, s33, 3
    s_add_u32 s40, s40, s37
    s_lshl_b32 s40, s40, 11
    s_add_u32 s40, s40, 0x140000
    s_waitcnt vmcnt(20)
    v_perm_b32 v176, v20, v20, v2
    v_perm_b32 v177, v20, v20, v4
    v_perm_b32 v178, v20, v20, v6
    v_perm_b32 v179, v20, v20, v8
    v_perm_b32 v180, v22, v22, v2
    v_perm_b32 v181, v22, v22, v4
    v_perm_b32 v182, v22, v22, v6
    v_perm_b32 v183, v22, v22, v8
    v_perm_b32 v184, v20, v20, v3
    v_perm_b32 v185, v20, v20, v5
    v_perm_b32 v186, v20, v20, v7
    v_perm_b32 v187, v20, v20, v9
    v_perm_b32 v188, v22, v22, v3
    v_perm_b32 v189, v22, v22, v5
    v_perm_b32 v190, v22, v22, v7
    v_perm_b32 v191, v22, v22, v9
    v_perm_b32 v192, v21, v21, v2
    v_perm_b32 v193, v21, v21, v4
    v_perm_b32 v194, v21, v21, v6
    v_perm_b32 v195, v21, v21, v8
    v_perm_b32 v196, v23, v23, v2
    v_perm_b32 v197, v23, v23, v4
    v_perm_b32 v198, v23, v23, v6
    v_perm_b32 v199, v23, v23, v8
    v_perm_b32 v200, v21, v21, v3
    v_perm_b32 v201, v21, v21, v5
    v_perm_b32 v202, v21, v21, v7
    v_perm_b32 v203, v21, v21, v9
    v_perm_b32 v204, v23, v23, v3
    v_perm_b32 v205, v23, v23, v5
    v_perm_b32 v206, v23, v23, v7
    v_perm_b32 v207, v23, v23, v9
    s_waitcnt vmcnt(19)
    v_mfma_f32_16x16x32_bf16 v[40:43], v[176:179], v[24:27], 0
    v_mfma_f32_16x16x32_bf16 v[44:47], v[180:183], v[24:27], 0
    s_waitcnt vmcnt(18)
    v_mfma_f32_16x16x32_bf16 v[40:43], v[184:187], v[28:31], v[40:43]
    v_mfma_f32_16x16x32_bf16 v[44:47], v[188:191], v[28:31], v[44:47]
    s_waitcnt vmcnt(17)
    v_mfma_f32_16x16x32_bf16 v[40:43], v[192:195], v[32:35], v[40:43]
    v_mfma_f32_16x16x32_bf16 v[44:47], v[196:199], v[32:35], v[44:47]
    s_waitcnt vmcnt(16)
    v_mfma_f32_16x16x32_bf16 v[40:43], v[200:203], v[36:39], v[40:43]
    v_mfma_f32_16x16x32_bf16 v[44:47], v[204:207], v[36:39], v[44:47]
    s_nop 6
    ds_write_b128 v19, v[40:43] offset:0
    ds_write_b128 v19, v[44:47] offset:1536
    s_waitcnt lgkmcnt(0)
    s_barrier
    s_cmp_ge_u32 s3, 2
    s_cbranch_scc1 nopub_39
    ds_read_b128 v[60:63], v58 offset:0
    ds_read_b128 v[64:67], v58 offset:3072
    ds_read_b128 v[68:71], v58 offset:6144
    ds_read_b128 v[72:75], v58 offset:9216
    ds_read_b128 v[76:79], v58 offset:12288
    ds_read_b128 v[80:83], v58 offset:15360
    ds_read_b128 v[84:87], v58 offset:18432
    ds_read_b128 v[88:91], v58 offset:21504
    v_mov_b32 v94, v16
    v_mov_b32 v95, 0
    s_waitcnt lgkmcnt(4)
    v_pk_add_f32 v[60:61], v[60:61], v[64:65]
    v_pk_add_f32 v[62:63], v[62:63], v[66:67]
    v_pk_add_f32 v[68:69], v[68:69], v[72:73]
    v_pk_add_f32 v[70:71], v[70:71], v[74:75]
    v_pk_add_f32 v[60:61], v[60:61], v[68:69]
    v_pk_add_f32 v[62:63], v[62:63], v[70:71]
    s_waitcnt lgkmcnt(0)
    v_pk_add_f32 v[76:77], v[76:77], v[80:81]
    v_pk_add_f32 v[78:79], v[78:79], v[82:83]
    v_pk_add_f32 v[84:85], v[84:85], v[88:89]
    v_pk_add_f32 v[86:87], v[86:87], v[90:91]
    v_pk_add_f32 v[76:77], v[76:77], v[84:85]
    v_pk_add_f32 v[78:79], v[78:79], v[86:87]
    v_pk_add_f32 v[60:61], v[60:61], v[76:77]
    v_pk_add_f32 v[62:63], v[62:63], v[78:79]
    v_cvt_pk_bf16_f32 v92, v60, v61
    v_cvt_pk_bf16_f32 v93, v62, v63
    buffer_store_dwordx4 v[92:95], v57, s[44:47], s40 offen sc1
nopub_39:
    s_nop 3
    s_barrier
    s_mov_b32 s42, 0
    s_add_u32 s36, s77, 0
    s_mov_b32 m0, s36
    s_add_u32 s37, s76, 0
    buffer_load_dwordx4 v169, s[44:47], s37 offen lds
    s_add_u32 s36, s77, 1024
    s_mov_b32 m0, s36
    s_add_u32 s37, s76, 1024
    buffer_load_dwordx4 v170, s[44:47], s37 offen lds
    s_add_u32 s36, s77, 2048
    s_mov_b32 m0, s36
    s_add_u32 s37, s76, 2048
    buffer_load_dwordx4 v171, s[44:47], s37 offen lds
    s_add_u32 s36, s77, 3072
    s_mov_b32 m0, s36
    s_add_u32 s37, s76, 3072
    buffer_load_dwordx4 v172, s[44:47], s37 offen lds
    s_waitcnt vmcnt(0)
    ds_read_b128 v[48:51], v173 offset:0
    ds_read_b128 v[52:55], v173 offset:1024
    ds_read_b128 v[56:59], v173 offset:2048
    ds_read_b128 v[60:63], v173 offset:3072
    s_waitcnt lgkmcnt(0)
    v_xor_b32 v64, v48, v164
    v_bitop3_b32 v64, v49, v165, v64 bitop3:0xbe
    v_bitop3_b32 v64, v50, v166, v64 bitop3:0xbe
    v_bitop3_b32 v64, v51, v167, v64 bitop3:0xbe
    v_bitop3_b32 v64, v52, v164, v64 bitop3:0xbe
    v_bitop3_b32 v64, v53, v165, v64 bitop3:0xbe
    v_bitop3_b32 v64, v54, v166, v64 bitop3:0xbe
    v_bitop3_b32 v64, v55, v167, v64 bitop3:0xbe
    v_bitop3_b32 v64, v56, v164, v64 bitop3:0xbe
    v_bitop3_b32 v64, v57, v165, v64 bitop3:0xbe
    v_bitop3_b32 v64, v58, v166, v64 bitop3:0xbe
    v_bitop3_b32 v64, v59, v167, v64 bitop3:0xbe
    v_bitop3_b32 v64, v60, v164, v64 bitop3:0xbe
    v_bitop3_b32 v64, v61, v165, v64 bitop3:0xbe
    v_bitop3_b32 v64, v62, v166, v64 bitop3:0xbe
    v_bitop3_b32 v64, v63, v167, v64 bitop3:0xbe
    v_and_b32 v64, 0x00010001, v64
    v_cmp_ne_u32 vcc, 0, v64
    s_cbranch_vccz q1d_43
    s_mov_b64 exec, 0xf
h1_40:
    buffer_load_dwordx4 v[48:51], v168, s[44:47], s76 offen sc1
    s_add_u32 s42, s42, 1
    s_waitcnt vmcnt(0)
    v_xor_b32 v52, v48, v240
    v_bitop3_b32 v52, v49, v241, v52 bitop3:0xbe
    v_bitop3_b32 v52, v50, v242, v52 bitop3:0xbe
    v_bitop3_b32 v52, v51, v243, v52 bitop3:0xbe
    v_and_b32 v52, 0x00010001, v52
    v_cmp_ne_u32 vcc, 0, v52
    s_cbranch_vccz h1d_41
    s_sleep 4
    s_cmp_lt_u32 s42, 0x20000
    s_cbranch_scc1 h1_40
h1d_41:
    s_mov_b64 exec, -1
    s_add_u32 s36, s77, 0
    s_mov_b32 m0, s36
    s_add_u32 s37, s76, 0
    buffer_load_dwordx4 v169, s[44:47], s37 offen sc1 lds
    s_add_u32 s36, s77, 1024
    s_mov_b32 m0, s36
    s_add_u32 s37, s76, 1024
    buffer_load_dwordx4 v170, s[44:47], s37 offen sc1 lds
    s_add_u32 s36, s77, 2048
    s_mov_b32 m0, s36
    s_add_u32 s37, s76, 2048
    buffer_load_dwordx4 v171, s[44:47], s37 offen sc1 lds
    s_add_u32 s36, s77, 3072
    s_mov_b32 m0, s36
    s_add_u32 s37, s76, 3072
    buffer_load_dwordx4 v172, s[44:47], s37 offen sc1 lds
q1_42:
    s_waitcnt vmcnt(0)
    ds_read_b128 v[48:51], v173 offset:0
    ds_read_b128 v[52:55], v173 offset:1024
    ds_read_b128 v[56:59], v173 offset:2048
    ds_read_b128 v[60:63], v173 offset:3072
    s_waitcnt lgkmcnt(0)
    v_xor_b32 v64, v48, v164
    v_bitop3_b32 v64, v49, v165, v64 bitop3:0xbe
    v_bitop3_b32 v64, v50, v166, v64 bitop3:0xbe
    v_bitop3_b32 v64, v51, v167, v64 bitop3:0xbe
    v_bitop3_b32 v64, v52, v164, v64 bitop3:0xbe
    v_bitop3_b32 v64, v53, v165, v64 bitop3:0xbe
    v_bitop3_b32 v64, v54, v166, v64 bitop3:0xbe
    v_bitop3_b32 v64, v55, v167, v64 bitop3:0xbe
    v_bitop3_b32 v64, v56, v164, v64 bitop3:0xbe
    v_bitop3_b32 v64, v57, v165, v64 bitop3:0xbe
    v_bitop3_b32 v64, v58, v166, v64 bitop3:0xbe
    v_bitop3_b32 v64, v59, v167, v64 bitop3:0xbe
    v_bitop3_b32 v64, v60, v164, v64 bitop3:0xbe
    v_bitop3_b32 v64, v61, v165, v64 bitop3:0xbe
    v_bitop3_b32 v64, v62, v166, v64 bitop3:0xbe
    v_bitop3_b32 v64, v63, v167, v64 bitop3:0xbe
    v_and_b32 v64, 0x00010001, v64
    v_cmp_ne_u32 vcc, 0, v64
    s_cbranch_vccz q1d_43
    s_add_u32 s42, s42, 1
    s_sleep 4
    s_add_u32 s36, s77, 0
    s_mov_b32 m0, s36
    s_add_u32 s37, s76, 0
    buffer_load_dwordx4 v169, s[44:47], s37 offen sc1 lds
    s_add_u32 s36, s77, 1024
    s_mov_b32 m0, s36
    s_add_u32 s37, s76, 1024
    buffer_load_dwordx4 v170, s[44:47], s37 offen sc1 lds
    s_add_u32 s36, s77, 2048
    s_mov_b32 m0, s36
    s_add_u32 s37, s76, 2048
    buffer_load_dwordx4 v171, s[44:47], s37 offen sc1 lds
    s_add_u32 s36, s77, 3072
    s_mov_b32 m0, s36
    s_add_u32 s37, s76, 3072
    buffer_load_dwordx4 v172, s[44:47], s37 offen sc1 lds
    s_cmp_lt_u32 s42, 0x20000
    s_cbranch_scc1 q1_42
    s_waitcnt vmcnt(0)
q1d_43:
    v_mov_b32 v64, 0xfffefffe
    v_and_b32 v48, v64, v48
    v_and_b32 v49, v64, v49
    v_and_b32 v50, v64, v50
    v_and_b32 v51, v64, v51
    ds_write_b128 v173, v[48:51] offset:0
    v_and_b32 v52, v64, v52
    v_and_b32 v53, v64, v53
    v_and_b32 v54, v64, v54
    v_and_b32 v55, v64, v55
    ds_write_b128 v173, v[52:55] offset:1024
    v_and_b32 v56, v64, v56
    v_and_b32 v57, v64, v57
    v_and_b32 v58, v64, v58
    v_and_b32 v59, v64, v59
    ds_write_b128 v173, v[56:59] offset:2048
    v_and_b32 v60, v64, v60
    v_and_b32 v61, v64, v61
    v_and_b32 v62, v64, v62
    v_and_b32 v63, v64, v63
    ds_write_b128 v173, v[60:63] offset:3072
    s_mov_b32 s79, 0x3e0293ee
    s_waitcnt lgkmcnt(0)
    s_barrier
    s_cmp_ge_u32 s3, 4
    s_cbranch_scc1 attnA_idle_44
    ds_read_b128 v[48:51], v128 offset:0
    ds_read_b128 v[80:83], v136 offset:0
    ds_read_b128 v[52:55], v129 offset:0
    ds_read_b128 v[84:87], v137 offset:0
    ds_read_b128 v[56:59], v130 offset:0
    ds_read_b128 v[88:91], v138 offset:0
    ds_read_b128 v[60:63], v131 offset:0
    ds_read_b128 v[92:95], v139 offset:0
    ds_read_b128 v[64:67], v132 offset:0
    ds_read_b128 v[96:99], v140 offset:0
    ds_read_b128 v[68:71], v133 offset:0
    ds_read_b128 v[100:103], v141 offset:0
    s_waitcnt lgkmcnt(10)
    v_mfma_f32_32x32x16_bf16 v[32:47], v[48:51], v[80:83], 0
    ds_read_b128 v[72:75], v134 offset:0
    ds_read_b128 v[104:107], v142 offset:0
    s_waitcnt lgkmcnt(10)
    v_mfma_f32_32x32x16_bf16 v[32:47], v[52:55], v[84:87], v[32:47]
    ds_read_b128 v[76:79], v135 offset:0
    ds_read_b128 v[108:111], v143 offset:0
    s_waitcnt lgkmcnt(10)
    v_mfma_f32_32x32x16_bf16 v[32:47], v[56:59], v[88:91], v[32:47]
    ds_read_b128 v[48:51], v128 offset:256
    ds_read_b128 v[80:83], v136 offset:256
    s_waitcnt lgkmcnt(10)
    v_mfma_f32_32x32x16_bf16 v[32:47], v[60:63], v[92:95], v[32:47]
    ds_read_b128 v[52:55], v129 offset:256
    ds_read_b128 v[84:87], v137 offset:256
    s_waitcnt lgkmcnt(10)
    v_mfma_f32_32x32x16_bf16 v[32:47], v[64:67], v[96:99], v[32:47]
    ds_read_b128 v[56:59], v130 offset:256
    ds_read_b128 v[88:91], v138 offset:256
    s_waitcnt lgkmcnt(10)
    v_mfma_f32_32x32x16_bf16 v[32:47], v[68:71], v[100:103], v[32:47]
    ds_read_b128 v[60:63], v131 offset:256
    ds_read_b128 v[92:95], v139 offset:256
    s_waitcnt lgkmcnt(10)
    v_mfma_f32_32x32x16_bf16 v[32:47], v[72:75], v[104:107], v[32:47]
    ds_read_b128 v[64:67], v132 offset:256
    ds_read_b128 v[96:99], v140 offset:256
    s_waitcnt lgkmcnt(10)
    v_mfma_f32_32x32x16_bf16 v[32:47], v[76:79], v[108:111], v[32:47]
    ds_read_b128 v[68:71], v133 offset:256
    ds_read_b128 v[100:103], v141 offset:256
    s_waitcnt lgkmcnt(10)
    v_mfma_f32_32x32x16_bf16 v[32:47], v[48:51], v[80:83], v[32:47]
    ds_read_b128 v[72:75], v134 offset:256
    ds_read_b128 v[104:107], v142 offset:256
    s_waitcnt lgkmcnt(10)
    v_mfma_f32_32x32x16_bf16 v[32:47], v[52:55], v[84:87], v[32:47]
    ds_read_b128 v[76:79], v135 offset:256
    ds_read_b128 v[108:111], v143 offset:256
    s_waitcnt lgkmcnt(10)
    v_mfma_f32_32x32x16_bf16 v[32:47], v[56:59], v[88:91], v[32:47]
    ds_read_b128 v[48:51], v128 offset:512
    ds_read_b128 v[80:83], v136 offset:512
    s_waitcnt lgkmcnt(10)
    v_mfma_f32_32x32x16_bf16 v[32:47], v[60:63], v[92:95], v[32:47]
    ds_read_b128 v[52:55], v129 offset:512
    ds_read_b128 v[84:87], v137 offset:512
    s_waitcnt lgkmcnt(10)
    v_mfma_f32_32x32x16_bf16 v[32:47], v[64:67], v[96:99], v[32:47]
    ds_read_b128 v[56:59], v130 offset:512
    ds_read_b128 v[88:91], v138 offset:512
    s_waitcnt lgkmcnt(10)
    v_mfma_f32_32x32x16_bf16 v[32:47], v[68:71], v[100:103], v[32:47]
    ds_read_b128 v[60:63], v131 offset:512
    ds_read_b128 v[92:95], v139 offset:512
    s_waitcnt lgkmcnt(10)
    v_mfma_f32_32x32x16_bf16 v[32:47], v[72:75], v[104:107], v[32:47]
    ds_read_b128 v[64:67], v132 offset:512
    ds_read_b128 v[96:99], v140 offset:512
    s_waitcnt lgkmcnt(10)
    v_mfma_f32_32x32x16_bf16 v[32:47], v[76:79], v[108:111], v[32:47]
    ds_read_b128 v[68:71], v133 offset:512
    ds_read_b128 v[100:103], v141 offset:512
    s_waitcnt lgkmcnt(10)
    v_mfma_f32_32x32x16_bf16 v[32:47], v[48:51], v[80:83], v[32:47]
    ds_read_b128 v[72:75], v134 offset:512
    ds_read_b128 v[104:107], v142 offset:512
    s_waitcnt lgkmcnt(10)
    v_mfma_f32_32x32x16_bf16 v[32:47], v[52:55], v[84:87], v[32:47]
    ds_read_b128 v[76:79], v135 offset:512
    ds_read_b128 v[108:111], v143 offset:512
    s_waitcnt lgkmcnt(10)
    v_mfma_f32_32x32x16_bf16 v[32:47], v[56:59], v[88:91], v[32:47]
    ds_read_b128 v[48:51], v128 offset:768
    ds_read_b128 v[80:83], v136 offset:768
    s_waitcnt lgkmcnt(10)
    v_mfma_f32_32x32x16_bf16 v[32:47], v[60:63], v[92:95], v[32:47]
    ds_read_b128 v[52:55], v129 offset:768
    ds_read_b128 v[84:87], v137 offset:768
    s_waitcnt lgkmcnt(10)
    v_mfma_f32_32x32x16_bf16 v[32:47], v[64:67], v[96:99], v[32:47]
    ds_read_b128 v[56:59], v130 offset:768
    ds_read_b128 v[88:91], v138 offset:768
    s_waitcnt lgkmcnt(10)
    v_mfma_f32_32x32x16_bf16 v[32:47], v[68:71], v[100:103], v[32:47]
    ds_read_b128 v[60:63], v131 offset:768
    ds_read_b128 v[92:95], v139 offset:768
    s_waitcnt lgkmcnt(10)
    v_mfma_f32_32x32x16_bf16 v[32:47], v[72:75], v[104:107], v[32:47]
    ds_read_b128 v[64:67], v132 offset:768
    ds_read_b128 v[96:99], v140 offset:768
    s_waitcnt lgkmcnt(10)
    v_mfma_f32_32x32x16_bf16 v[32:47], v[76:79], v[108:111], v[32:47]
    ds_read_b128 v[68:71], v133 offset:768
    ds_read_b128 v[100:103], v141 offset:768
    s_waitcnt lgkmcnt(10)
    v_mfma_f32_32x32x16_bf16 v[32:47], v[48:51], v[80:83], v[32:47]
    ds_read_b128 v[72:75], v134 offset:768
    ds_read_b128 v[104:107], v142 offset:768
    s_waitcnt lgkmcnt(10)
    v_mfma_f32_32x32x16_bf16 v[32:47], v[52:55], v[84:87], v[32:47]
    ds_read_b128 v[76:79], v135 offset:768
    ds_read_b128 v[108:111], v143 offset:768
    s_waitcnt lgkmcnt(10)
    v_mfma_f32_32x32x16_bf16 v[32:47], v[56:59], v[88:91], v[32:47]
    s_waitcnt lgkmcnt(8)
    v_mfma_f32_32x32x16_bf16 v[32:47], v[60:63], v[92:95], v[32:47]
    s_waitcnt lgkmcnt(6)
    v_mfma_f32_32x32x16_bf16 v[32:47], v[64:67], v[96:99], v[32:47]
    s_waitcnt lgkmcnt(4)
    v_mfma_f32_32x32x16_bf16 v[32:47], v[68:71], v[100:103], v[32:47]
    s_waitcnt lgkmcnt(2)
    v_mfma_f32_32x32x16_bf16 v[32:47], v[72:75], v[104:107], v[32:47]
    s_waitcnt lgkmcnt(0)
    v_mfma_f32_32x32x16_bf16 v[32:47], v[76:79], v[108:111], v[32:47]
    s_nop 11
    v_max3_f32 v112, v32, v33, v34
    v_max3_f32 v112, v112, v35, v36
    v_max3_f32 v112, v112, v37, v38
    v_max3_f32 v112, v112, v39, v40
    v_max3_f32 v112, v112, v41, v42
    v_max3_f32 v112, v112, v43, v44
    v_max3_f32 v112, v112, v45, v46
    v_max_f32 v112, v112, v47
    v_mov_b32 v113, v112
    s_nop 1
    v_permlane32_swap_b32 v112, v113
    v_max_f32 v112, v112, v113
    s_barrier
    ds_write_b32 v153, v112
    s_waitcnt lgkmcnt(0)
    s_barrier
    ds_read_b32 v116, v152 offset:0
    ds_read_b32 v117, v152 offset:128
    ds_read_b32 v118, v152 offset:256
    ds_read_b32 v119, v152 offset:384
    s_waitcnt lgkmcnt(0)
    v_max3_f32 v112, v116, v117, v118
    v_max_f32 v112, v112, v119
    v_mul_f32 v112, s79, v112
    v_mov_b32 v116, s79
    v_mov_b32 v117, s79
    v_sub_f32 v118, 0, v112
    v_mov_b32 v119, v118
    v_pk_fma_f32 v[32:33], v[32:33], v[116:117], v[118:119]
    v_pk_fma_f32 v[34:35], v[34:35], v[116:117], v[118:119]
    v_pk_fma_f32 v[36:37], v[36:37], v[116:117], v[118:119]
    v_pk_fma_f32 v[38:39], v[38:39], v[116:117], v[118:119]
    v_pk_fma_f32 v[40:41], v[40:41], v[116:117], v[118:119]
    v_pk_fma_f32 v[42:43], v[42:43], v[116:117], v[118:119]
    v_pk_fma_f32 v[44:45], v[44:45], v[116:117], v[118:119]
    v_pk_fma_f32 v[46:47], v[46:47], v[116:117], v[118:119]
    v_exp_f32 v32, v32
    v_exp_f32 v33, v33
    v_exp_f32 v34, v34
    v_exp_f32 v35, v35
    v_exp_f32 v36, v36
    v_exp_f32 v37, v37
    v_exp_f32 v38, v38
    v_exp_f32 v39, v39
    v_exp_f32 v40, v40
    v_exp_f32 v41, v41
    v_exp_f32 v42, v42
    v_exp_f32 v43, v43
    v_exp_f32 v44, v44
    v_exp_f32 v45, v45
    v_exp_f32 v46, v46
    v_exp_f32 v47, v47
    v_cvt_pk_bf16_f32 v48, v32, v33
    v_cvt_pk_bf16_f32 v49, v34, v35
    v_cvt_pk_bf16_f32 v50, v36, v37
    v_cvt_pk_bf16_f32 v51, v38, v39
    v_cvt_pk_bf16_f32 v52, v40, v41
    v_cvt_pk_bf16_f32 v53, v42, v43
    v_cvt_pk_bf16_f32 v54, v44, v45
    v_cvt_pk_bf16_f32 v55, v46, v47
    ds_write_b128 v155, v[48:51]
    ds_write_b128 v155, v[52:55] offset:1024
    v_pk_add_f32 v[32:33], v[32:33], v[40:41]
    v_pk_add_f32 v[34:35], v[34:35], v[42:43]
    v_pk_add_f32 v[36:37], v[36:37], v[44:45]
    v_pk_add_f32 v[38:39], v[38:39], v[46:47]
    v_pk_add_f32 v[32:33], v[32:33], v[36:37]
    v_pk_add_f32 v[34:35], v[34:35], v[38:39]
    v_pk_add_f32 v[32:33], v[32:33], v[34:35]
    v_add_f32 v115, v32, v33
    v_mov_b32 v116, v115
    s_nop 1
    v_permlane32_swap_b32 v115, v116
    v_add_f32 v115, v115, v116
    ds_write_b32 v153, v115 offset:512
    s_branch attnA_join_45
attnA_idle_44:
    s_nop 2
    s_mov_b32 s48, s12
    s_and_b32 s49, s13, 0xffff
    s_mov_b32 s50, 0x400000
    s_mov_b32 s51, 0x20000
    v_lshlrev_b32 v244, 15, v10
    v_lshl_add_u32 v244, v11, 4, v244
    s_lshl_b32 s36, s43, 17
    s_lshl_b32 s37, s32, 8
    s_add_u32 s36, s36, s37
    s_add_u32 s37, s36, 0
    buffer_load_dwordx4 v[208:211], v244, s[48:51], s37 offen nt
    s_add_u32 s37, s36, 8192
    buffer_load_dwordx4 v[212:215], v244, s[48:51], s37 offen nt
    s_add_u32 s37, s36, 16384
    buffer_load_dwordx4 v[216:219], v244, s[48:51], s37 offen nt
    s_add_u32 s37, s36, 24576
    buffer_load_dwordx4 v[220:223], v244, s[48:51], s37 offen nt
    s_barrier
    s_barrier
attnA_join_45:
    s_waitcnt lgkmcnt(0)
    s_barrier
    s_cmp_ge_u32 s3, 4
    s_cbranch_scc1 late03_46
    s_mov_b32 s48, s12
    s_and_b32 s49, s13, 0xffff
    s_mov_b32 s50, 0x400000
    s_mov_b32 s51, 0x20000
    v_lshlrev_b32 v244, 15, v10
    v_lshl_add_u32 v244, v11, 4, v244
    s_lshl_b32 s36, s43, 17
    s_lshl_b32 s37, s32, 8
    s_add_u32 s36, s36, s37
    s_add_u32 s37, s36, 0
    buffer_load_dwordx4 v[208:211], v244, s[48:51], s37 offen nt
    s_add_u32 s37, s36, 8192
    buffer_load_dwordx4 v[212:215], v244, s[48:51], s37 offen nt
    s_add_u32 s37, s36, 16384
    buffer_load_dwordx4 v[216:219], v244, s[48:51], s37 offen nt
    s_add_u32 s37, s36, 24576
    buffer_load_dwordx4 v[220:223], v244, s[48:51], s37 offen nt
late03_46:
    s_cmp_lg_u32 s3, 0
    s_cbranch_scc1 nostat_47
    ds_read_b32 v120, v152 offset:512
    ds_read_b32 v121, v152 offset:640
    ds_read_b32 v122, v152 offset:768
    ds_read_b32 v123, v152 offset:896
    s_lshl_b32 s37, s66, 5
    s_add_u32 s37, s37, s67
    s_lshl_b32 s37, s37, 9
    s_add_u32 s37, s37, 0x40000
    s_waitcnt lgkmcnt(0)
    v_add_f32 v120, v120, v121
    v_add_f32 v122, v122, v123
    v_add_f32 v121, v120, v122
    v_mov_b32 v120, v112
    v_mov_b32 v122, v16
    v_mov_b32 v123, 0
    s_mov_b32 exec_lo, -1
    s_mov_b32 exec_hi, 0
    buffer_store_dwordx4 v[120:123], v162, s[44:47], s37 offen sc1
    s_mov_b64 exec, -1
nostat_47:
    s_nop 0
    ds_read_b128 v[48:51], v154 offset:0
    ds_read_b128 v[52:55], v154 offset:1024
    ds_read_b128 v[56:59], v154 offset:2048
    ds_read_b128 v[60:63], v154 offset:3072
    ds_read_b128 v[64:67], v154 offset:4096
    ds_read_b128 v[68:71], v154 offset:5120
    ds_read_b128 v[72:75], v154 offset:6144
    ds_read_b128 v[76:79], v154 offset:7168
    ds_read_b64_tr_b16 v[176:177], v144 offset:0
    ds_read_b64_tr_b16 v[178:179], v145 offset:8192
    ds_read_b64_tr_b16 v[180:181], v146 offset:0
    ds_read_b64_tr_b16 v[182:183], v147 offset:8192
    ds_read_b64_tr_b16 v[184:185], v144 offset:16384
    ds_read_b64_tr_b16 v[186:187], v145 offset:24576
    s_waitcnt lgkmcnt(4)
    v_mfma_f32_32x32x16_bf16 v[80:95], v[176:179], v[48:51], 0
    ds_read_b64_tr_b16 v[188:189], v146 offset:16384
    ds_read_b64_tr_b16 v[190:191], v147 offset:24576
    ds_read_b64_tr_b16 v[192:193], v144 offset:32768
    ds_read_b64_tr_b16 v[194:195], v145 offset:40960
    s_waitcnt lgkmcnt(6)
    v_mfma_f32_32x32x16_bf16 v[96:111], v[180:183], v[48:51], 0
    ds_read_b64_tr_b16 v[196:197], v146 offset:32768
    ds_read_b64_tr_b16 v[198:199], v147 offset:40960
    s_waitcnt lgkmcnt(6)
    v_mfma_f32_32x32x16_bf16 v[80:95], v[184:187], v[52:55], v[80:95]
    ds_read_b64_tr_b16 v[200:201], v144 offset:49152
    ds_read_b64_tr_b16 v[202:203], v145 offset:57344
    s_waitcnt lgkmcnt(6)
    v_mfma_f32_32x32x16_bf16 v[96:111], v[188:191], v[52:55], v[96:111]
    ds_read_b64_tr_b16 v[204:205], v146 offset:49152
    ds_read_b64_tr_b16 v[206:207], v147 offset:57344
    s_waitcnt lgkmcnt(6)
    v_mfma_f32_32x32x16_bf16 v[80:95], v[192:195], v[56:59], v[80:95]
    ds_read_b64_tr_b16 v[176:177], v148 offset:0
    ds_read_b64_tr_b16 v[178:179], v149 offset:8192
    s_waitcnt lgkmcnt(6)
    v_mfma_f32_32x32x16_bf16 v[96:111], v[196:199], v[56:59], v[96:111]
    ds_read_b64_tr_b16 v[180:181], v150 offset:0
    ds_read_b64_tr_b16 v[182:183], v151 offset:8192
    s_waitcnt lgkmcnt(6)
    v_mfma_f32_32x32x16_bf16 v[80:95], v[200:203], v[60:63], v[80:95]
    ds_read_b64_tr_b16 v[184:185], v148 offset:16384
    ds_read_b64_tr_b16 v[186:187], v149 offset:24576
    s_waitcnt lgkmcnt(6)
    v_mfma_f32_32x32x16_bf16 v[96:111], v[204:207], v[60:63], v[96:111]
    ds_read_b64_tr_b16 v[188:189], v150 offset:16384
    ds_read_b64_tr_b16 v[190:191], v151 offset:24576
    s_waitcnt lgkmcnt(6)
    v_mfma_f32_32x32x16_bf16 v[80:95], v[176:179], v[64:67], v[80:95]
    ds_read_b64_tr_b16 v[192:193], v148 offset:32768
    ds_read_b64_tr_b16 v[194:195], v149 offset:40960
    s_waitcnt lgkmcnt(6)
    v_mfma_f32_32x32x16_bf16 v[96:111], v[180:183], v[64:67], v[96:111]
    ds_read_b64_tr_b16 v[196:197], v150 offset:32768
    ds_read_b64_tr_b16 v[198:199], v151 offset:40960
    s_waitcnt lgkmcnt(6)
    v_mfma_f32_32x32x16_bf16 v[80:95], v[184:187], v[68:71], v[80:95]
    ds_read_b64_tr_b16 v[200:201], v148 offset:49152
    ds_read_b64_tr_b16 v[202:203], v149 offset:57344
    s_waitcnt lgkmcnt(6)
    v_mfma_f32_32x32x16_bf16 v[96:111], v[188:191], v[68:71], v[96:111]
    ds_read_b64_tr_b16 v[204:205], v150 offset:49152
    ds_read_b64_tr_b16 v[206:207], v151 offset:57344
    s_waitcnt lgkmcnt(6)
    v_mfma_f32_32x32x16_bf16 v[80:95], v[192:195], v[72:75], v[80:95]
    s_waitcnt lgkmcnt(4)
    v_mfma_f32_32x32x16_bf16 v[96:111], v[196:199], v[72:75], v[96:111]
    s_waitcnt lgkmcnt(2)
    v_mfma_f32_32x32x16_bf16 v[80:95], v[200:203], v[76:79], v[80:95]
    s_waitcnt lgkmcnt(0)
    v_mfma_f32_32x32x16_bf16 v[96:111], v[204:207], v[76:79], v[96:111]
    s_barrier
    s_nop 8
    v_cvt_pk_bf16_f32 v176, v80, v81
    v_cvt_pk_bf16_f32 v177, v82, v83
    ds_write_b64 v156, v[176:177] offset:0
    v_cvt_pk_bf16_f32 v178, v84, v85
    v_cvt_pk_bf16_f32 v179, v86, v87
    ds_write_b64 v156, v[178:179] offset:16
    v_cvt_pk_bf16_f32 v180, v88, v89
    v_cvt_pk_bf16_f32 v181, v90, v91
    ds_write_b64 v156, v[180:181] offset:32
    v_cvt_pk_bf16_f32 v182, v92, v93
    v_cvt_pk_bf16_f32 v183, v94, v95
    ds_write_b64 v156, v[182:183] offset:48
    v_cvt_pk_bf16_f32 v184, v96, v97
    v_cvt_pk_bf16_f32 v185, v98, v99
    ds_write_b64 v156, v[184:185] offset:64
    v_cvt_pk_bf16_f32 v186, v100, v101
    v_cvt_pk_bf16_f32 v187, v102, v103
    ds_write_b64 v156, v[186:187] offset:80
    v_cvt_pk_bf16_f32 v188, v104, v105
    v_cvt_pk_bf16_f32 v189, v106, v107
    ds_write_b64 v156, v[188:189] offset:96
    v_cvt_pk_bf16_f32 v190, v108, v109
    v_cvt_pk_bf16_f32 v191, v110, v111
    ds_write_b64 v156, v[190:191] offset:112
    s_lshl_b32 s37, s66, 5
    s_add_u32 s41, s37, s67
    s_lshl_b32 s36, s41, 15
    s_add_u32 s36, s36, 0x200000
    s_waitcnt lgkmcnt(0)
    s_barrier
    ds_read_b128 v[32:35], v160 offset:0
    ds_read_b128 v[36:39], v160 offset:8320
    ds_read_b128 v[40:43], v160 offset:16640
    ds_read_b128 v[44:47], v160 offset:24960
    s_waitcnt lgkmcnt(3)
    v_bfi_b32 v32, v163, v240, v32
    v_bfi_b32 v33, v163, v241, v33
    v_bfi_b32 v34, v163, v242, v34
    v_bfi_b32 v35, v163, v243, v35
    s_add_u32 s37, s36, 0
    buffer_store_dwordx4 v[32:35], v161, s[44:47], s37 offen sc1
    s_waitcnt lgkmcnt(2)
    v_bfi_b32 v36, v163, v240, v36
    v_bfi_b32 v37, v163, v241, v37
    v_bfi_b32 v38, v163, v242, v38
    v_bfi_b32 v39, v163, v243, v39
    s_add_u32 s37, s36, 8192
    buffer_store_dwordx4 v[36:39], v161, s[44:47], s37 offen sc1
    s_waitcnt lgkmcnt(1)
    v_bfi_b32 v40, v163, v240, v40
    v_bfi_b32 v41, v163, v241, v41
    v_bfi_b32 v42, v163, v242, v42
    v_bfi_b32 v43, v163, v243, v43
    s_add_u32 s37, s36, 16384
    buffer_store_dwordx4 v[40:43], v161, s[44:47], s37 offen sc1
    s_waitcnt lgkmcnt(0)
    v_bfi_b32 v44, v163, v240, v44
    v_bfi_b32 v45, v163, v241, v45
    v_bfi_b32 v46, v163, v242, v46
    v_bfi_b32 v47, v163, v243, v47
    s_add_u32 s37, s36, 24576
    buffer_store_dwordx4 v[44:47], v161, s[44:47], s37 offen sc1
    s_branch doneA_2
doneA_2:
    s_nop 1
    v_lshrrev_b32 v96, 3, v11
    v_lshlrev_b32 v96, 7, v96
    v_lshl_add_u32 v96, v10, 5, v96
    s_lshl_b32 s36, s3, 2
    v_add_u32 v96, s36, v96
    v_lshrrev_b32 v97, 5, v1
    v_mul_u32_u24 v97, 768, v97
    v_lshl_add_u32 v97, v11, 4, v97
    v_and_b32 v98, 1, v10
    v_mul_u32_u24 v98, 384, v98
    v_add_u32 v97, v97, v98
    s_mul_i32 s36, s3, 3072
    s_add_u32 s36, s36, 0x0
    v_add_u32 v97, s36, v97
    v_bfe_u32 v95, v0, 5, 2
    v_mul_u32_u24 v95, 768, v95
    v_and_b32 v98, 1, v0
    v_mul_u32_u24 v98, 384, v98
    v_add_u32 v95, v95, v98
    v_bfe_u32 v98, v0, 1, 4
    v_lshl_add_u32 v95, v98, 4, v95
    v_and_b32 v98, 127, v0
    v_lshlrev_b32 v98, 4, v98
    s_and_b32 s39, s3, 3
    v_lshlrev_b32 v112, 3, v11
    s_lshl_b32 s36, s39, 7
    v_add_u32 v112, s36, v112
    s_lshl_b32 s40, s32, 2
    s_add_u32 s40, s40, s33
    s_lshl_b32 s40, s40, 11
    s_add_u32 s40, s40, 0xb00000
    v_lshrrev_b32 v99, 3, v11
    v_lshlrev_b32 v99, 8, v99
    v_lshl_add_u32 v99, v10, 3, v99
    s_lshl_b32 s36, s3, 5
    v_add_u32 v99, s36, v99
    s_barrier
    s_cmp_ge_u32 s3, 4
    s_cbranch_scc1 e1other_48
    v_lshlrev_b32 v17, 18, v10
    v_lshl_add_u32 v17, v11, 4, v17
    s_lshl_b32 s36, s32, 2
    s_add_u32 s36, s36, s33
    s_lshl_b32 s36, s36, 8
    s_lshl_b32 s37, s3, 20
    s_add_u32 s36, s36, s37
    s_add_u32 s76, s36, 0x200000
    v_and_b32 v19, 31, v1
    v_lshlrev_b32 v19, 9, v19
    s_lshl_b32 s36, s32, 4
    s_lshl_b32 s37, s3, 14
    s_add_u32 s36, s36, s37
    s_add_u32 s78, s36, 0x40000
    s_lshl_b32 s36, s3, 6
    s_add_u32 s36, s36, 1536
    v_and_b32 v103, 31, v1
    v_lshlrev_b32 v103, 1, v103
    v_add_u32 v103, s36, v103
    v_lshlrev_b32 v102, 4, v10
    v_add_u32 v102, s36, v102
    v_lshlrev_b32 v101, 3, v10
    v_lshl_add_u32 v101, v11, 4, v101
    s_lshl_b32 s36, s3, 8
    v_add_u32 v101, s36, v101
    s_mov_b32 s42, 0
h2s_52:
    buffer_load_dwordx4 v[64:67], v19, s[44:47], s78 offen sc1
    s_add_u32 s42, s42, 1
    s_waitcnt vmcnt(0)
    v_cmp_ne_u32 s[74:75], s70, v66
    s_cmp_eq_u64 s[74:75], 0
    s_cbranch_scc1 h2sd_53
    s_sleep 8
    s_cmp_lt_u32 s42, 0x20000
    s_cbranch_scc1 h2s_52
h2sd_53:
    s_cmp_eq_u32 s42, 1
    s_cbranch_scc1 h2ns_55
    s_sleep 16
h2ns_55:
    s_add_u32 s37, s76, 0
    buffer_load_dwordx4 v[32:35], v17, s[44:47], s37 offen sc1
    s_add_u32 s37, s76, 32768
    buffer_load_dwordx4 v[36:39], v17, s[44:47], s37 offen sc1
    s_add_u32 s37, s76, 65536
    buffer_load_dwordx4 v[40:43], v17, s[44:47], s37 offen sc1
    s_add_u32 s37, s76, 98304
    buffer_load_dwordx4 v[44:47], v17, s[44:47], s37 offen sc1
    s_add_u32 s37, s76, 131072
    buffer_load_dwordx4 v[48:51], v17, s[44:47], s37 offen sc1
    s_add_u32 s37, s76, 163840
    buffer_load_dwordx4 v[52:55], v17, s[44:47], s37 offen sc1
    s_add_u32 s37, s76, 196608
    buffer_load_dwordx4 v[56:59], v17, s[44:47], s37 offen sc1
    s_add_u32 s37, s76, 229376
    buffer_load_dwordx4 v[60:63], v17, s[44:47], s37 offen sc1
h2f_54:
    v_mov_b32 v68, v64
    s_nop 1
    v_max_f32_dpp v68, v68, v68 row_ror:1 row_mask:0xf bank_mask:0xf
    s_nop 1
    v_max_f32_dpp v68, v68, v68 row_ror:2 row_mask:0xf bank_mask:0xf
    s_nop 1
    v_max_f32_dpp v68, v68, v68 row_ror:4 row_mask:0xf bank_mask:0xf
    s_nop 1
    v_max_f32_dpp v68, v68, v68 row_ror:8 row_mask:0xf bank_mask:0xf
    v_mov_b32 v69, v68
    s_nop 1
    v_permlane16_swap_b32 v68, v69
    v_max_f32 v68, v68, v69
    v_sub_f32 v64, v64, v68
    v_exp_f32 v64, v64
    s_nop 0
    v_mul_f32 v68, v64, v65
    s_nop 1
    v_add_f32_dpp v68, v68, v68 row_ror:1 row_mask:0xf bank_mask:0xf
    s_nop 1
    v_add_f32_dpp v68, v68, v68 row_ror:2 row_mask:0xf bank_mask:0xf
    s_nop 1
    v_add_f32_dpp v68, v68, v68 row_ror:4 row_mask:0xf bank_mask:0xf
    s_nop 1
    v_add_f32_dpp v68, v68, v68 row_ror:8 row_mask:0xf bank_mask:0xf
    v_mov_b32 v69, v68
    s_nop 1
    v_permlane16_swap_b32 v68, v69
    v_add_f32 v68, v68, v69
    v_rcp_f32 v68, v68
    s_nop 0
    v_mul_f32 v64, v64, v68
    v_cvt_pk_bf16_f32 v64, v64, v64
    ds_write_b16 v103, v64
    s_waitcnt lgkmcnt(0)
    ds_read_b128 v[84:87], v102
    s_waitcnt lgkmcnt(0)
    v_perm_b32 v128, v84, v84, v2
    v_perm_b32 v129, v84, v84, v4
    v_perm_b32 v130, v84, v84, v6
    v_perm_b32 v131, v84, v84, v8
    v_perm_b32 v132, v84, v84, v3
    v_perm_b32 v133, v84, v84, v5
    v_perm_b32 v134, v84, v84, v7
    v_perm_b32 v135, v84, v84, v9
    v_perm_b32 v136, v85, v85, v2
    v_perm_b32 v137, v85, v85, v4
    v_perm_b32 v138, v85, v85, v6
    v_perm_b32 v139, v85, v85, v8
    v_perm_b32 v140, v85, v85, v3
    v_perm_b32 v141, v85, v85, v5
    v_perm_b32 v142, v85, v85, v7
    v_perm_b32 v143, v85, v85, v9
    v_perm_b32 v144, v86, v86, v2
    v_perm_b32 v145, v86, v86, v4
    v_perm_b32 v146, v86, v86, v6
    v_perm_b32 v147, v86, v86, v8
    v_perm_b32 v148, v86, v86, v3
    v_perm_b32 v149, v86, v86, v5
    v_perm_b32 v150, v86, v86, v7
    v_perm_b32 v151, v86, v86, v9
    v_perm_b32 v152, v87, v87, v2
    v_perm_b32 v153, v87, v87, v4
    v_perm_b32 v154, v87, v87, v6
    v_perm_b32 v155, v87, v87, v8
    v_perm_b32 v156, v87, v87, v3
    v_perm_b32 v157, v87, v87, v5
    v_perm_b32 v158, v87, v87, v7
    v_perm_b32 v159, v87, v87, v9
    s_mov_b32 s42, 0
pm_56:
    s_waitcnt vmcnt(0)
    v_xor_b32 v70, v32, v240
    v_bitop3_b32 v70, v33, v241, v70 bitop3:0xbe
    v_bitop3_b32 v70, v34, v242, v70 bitop3:0xbe
    v_bitop3_b32 v70, v35, v243, v70 bitop3:0xbe
    v_bitop3_b32 v70, v36, v240, v70 bitop3:0xbe
    v_bitop3_b32 v70, v37, v241, v70 bitop3:0xbe
    v_bitop3_b32 v70, v38, v242, v70 bitop3:0xbe
    v_bitop3_b32 v70, v39, v243, v70 bitop3:0xbe
    v_bitop3_b32 v70, v40, v240, v70 bitop3:0xbe
    v_bitop3_b32 v70, v41, v241, v70 bitop3:0xbe
    v_bitop3_b32 v70, v42, v242, v70 bitop3:0xbe
    v_bitop3_b32 v70, v43, v243, v70 bitop3:0xbe
    v_bitop3_b32 v70, v44, v240, v70 bitop3:0xbe
    v_bitop3_b32 v70, v45, v241, v70 bitop3:0xbe
    v_bitop3_b32 v70, v46, v242, v70 bitop3:0xbe
    v_bitop3_b32 v70, v47, v243, v70 bitop3:0xbe
    v_bitop3_b32 v70, v48, v240, v70 bitop3:0xbe
    v_bitop3_b32 v70, v49, v241, v70 bitop3:0xbe
    v_bitop3_b32 v70, v50, v242, v70 bitop3:0xbe
    v_bitop3_b32 v70, v51, v243, v70 bitop3:0xbe
    v_bitop3_b32 v70, v52, v240, v70 bitop3:0xbe
    v_bitop3_b32 v70, v53, v241, v70 bitop3:0xbe
    v_bitop3_b32 v70, v54, v242, v70 bitop3:0xbe
    v_bitop3_b32 v70, v55, v243, v70 bitop3:0xbe
    v_bitop3_b32 v70, v56, v240, v70 bitop3:0xbe
    v_bitop3_b32 v70, v57, v241, v70 bitop3:0xbe
    v_bitop3_b32 v70, v58, v242, v70 bitop3:0xbe
    v_bitop3_b32 v70, v59, v243, v70 bitop3:0xbe
    v_bitop3_b32 v70, v60, v240, v70 bitop3:0xbe
    v_bitop3_b32 v70, v61, v241, v70 bitop3:0xbe
    v_bitop3_b32 v70, v62, v242, v70 bitop3:0xbe
    v_bitop3_b32 v70, v63, v243, v70 bitop3:0xbe
    v_and_b32 v70, 0x00010001, v70
    v_cmp_ne_u32 vcc, 0, v70
    s_cbranch_vccz pmd_57
    s_mov_b32 s74, 0
    v_xor_b32 v70, v32, v240
    v_bitop3_b32 v70, v33, v241, v70 bitop3:0xbe
    v_bitop3_b32 v70, v34, v242, v70 bitop3:0xbe
    v_bitop3_b32 v70, v35, v243, v70 bitop3:0xbe
    v_and_b32 v70, 0x00010001, v70
    v_cmp_ne_u32 vcc, 0, v70
    s_cbranch_vccz pms_58
    s_add_u32 s37, s76, 0
    buffer_load_dwordx4 v[32:35], v17, s[44:47], s37 offen sc1
    s_mov_b32 s74, 1
pms_58:
    v_xor_b32 v70, v36, v240
    v_bitop3_b32 v70, v37, v241, v70 bitop3:0xbe
    v_bitop3_b32 v70, v38, v242, v70 bitop3:0xbe
    v_bitop3_b32 v70, v39, v243, v70 bitop3:0xbe
    v_and_b32 v70, 0x00010001, v70
    v_cmp_ne_u32 vcc, 0, v70
    s_cbranch_vccz pms_59
    s_add_u32 s37, s76, 32768
    buffer_load_dwordx4 v[36:39], v17, s[44:47], s37 offen sc1
    s_mov_b32 s74, 1
pms_59:
    v_xor_b32 v70, v40, v240
    v_bitop3_b32 v70, v41, v241, v70 bitop3:0xbe
    v_bitop3_b32 v70, v42, v242, v70 bitop3:0xbe
    v_bitop3_b32 v70, v43, v243, v70 bitop3:0xbe
    v_and_b32 v70, 0x00010001, v70
    v_cmp_ne_u32 vcc, 0, v70
    s_cbranch_vccz pms_60
    s_add_u32 s37, s76, 65536
    buffer_load_dwordx4 v[40:43], v17, s[44:47], s37 offen sc1
    s_mov_b32 s74, 1
pms_60:
    v_xor_b32 v70, v44, v240
    v_bitop3_b32 v70, v45, v241, v70 bitop3:0xbe
    v_bitop3_b32 v70, v46, v242, v70 bitop3:0xbe
    v_bitop3_b32 v70, v47, v243, v70 bitop3:0xbe
    v_and_b32 v70, 0x00010001, v70
    v_cmp_ne_u32 vcc, 0, v70
    s_cbranch_vccz pms_61
    s_add_u32 s37, s76, 98304
    buffer_load_dwordx4 v[44:47], v17, s[44:47], s37 offen sc1
    s_mov_b32 s74, 1
pms_61:
    v_xor_b32 v70, v48, v240
    v_bitop3_b32 v70, v49, v241, v70 bitop3:0xbe
    v_bitop3_b32 v70, v50, v242, v70 bitop3:0xbe
    v_bitop3_b32 v70, v51, v243, v70 bitop3:0xbe
    v_and_b32 v70, 0x00010001, v70
    v_cmp_ne_u32 vcc, 0, v70
    s_cbranch_vccz pms_62
    s_add_u32 s37, s76, 131072
    buffer_load_dwordx4 v[48:51], v17, s[44:47], s37 offen sc1
    s_mov_b32 s74, 1
pms_62:
    v_xor_b32 v70, v52, v240
    v_bitop3_b32 v70, v53, v241, v70 bitop3:0xbe
    v_bitop3_b32 v70, v54, v242, v70 bitop3:0xbe
    v_bitop3_b32 v70, v55, v243, v70 bitop3:0xbe
    v_and_b32 v70, 0x00010001, v70
    v_cmp_ne_u32 vcc, 0, v70
    s_cbranch_vccz pms_63
    s_add_u32 s37, s76, 163840
    buffer_load_dwordx4 v[52:55], v17, s[44:47], s37 offen sc1
    s_mov_b32 s74, 1
pms_63:
    v_xor_b32 v70, v56, v240
    v_bitop3_b32 v70, v57, v241, v70 bitop3:0xbe
    v_bitop3_b32 v70, v58, v242, v70 bitop3:0xbe
    v_bitop3_b32 v70, v59, v243, v70 bitop3:0xbe
    v_and_b32 v70, 0x00010001, v70
    v_cmp_ne_u32 vcc, 0, v70
    s_cbranch_vccz pms_64
    s_add_u32 s37, s76, 196608
    buffer_load_dwordx4 v[56:59], v17, s[44:47], s37 offen sc1
    s_mov_b32 s74, 1
pms_64:
    v_xor_b32 v70, v60, v240
    v_bitop3_b32 v70, v61, v241, v70 bitop3:0xbe
    v_bitop3_b32 v70, v62, v242, v70 bitop3:0xbe
    v_bitop3_b32 v70, v63, v243, v70 bitop3:0xbe
    v_and_b32 v70, 0x00010001, v70
    v_cmp_ne_u32 vcc, 0, v70
    s_cbranch_vccz pms_65
    s_add_u32 s37, s76, 229376
    buffer_load_dwordx4 v[60:63], v17, s[44:47], s37 offen sc1
    s_mov_b32 s74, 1
pms_65:
    s_cmp_eq_u32 s74, 0
    s_cbranch_scc1 pmd_57
    s_add_u32 s42, s42, 1
    s_sleep 3
    s_cmp_lt_u32 s42, 0x20000
    s_cbranch_scc1 pm_56
    s_waitcnt vmcnt(0)
pmd_57:
    v_mov_b32 v70, 0xfffefffe
    v_and_b32 v32, v70, v32
    v_and_b32 v33, v70, v33
    v_and_b32 v34, v70, v34
    v_and_b32 v35, v70, v35
    v_and_b32 v36, v70, v36
    v_and_b32 v37, v70, v37
    v_and_b32 v38, v70, v38
    v_and_b32 v39, v70, v39
    v_and_b32 v40, v70, v40
    v_and_b32 v41, v70, v41
    v_and_b32 v42, v70, v42
    v_and_b32 v43, v70, v43
    v_and_b32 v44, v70, v44
    v_and_b32 v45, v70, v45
    v_and_b32 v46, v70, v46
    v_and_b32 v47, v70, v47
    v_mfma_f32_16x16x32_bf16 v[104:107], v[128:131], v[32:35], 0
    v_mfma_f32_16x16x32_bf16 v[76:79], v[132:135], v[36:39], 0
    v_and_b32 v48, v70, v48
    v_and_b32 v49, v70, v49
    v_and_b32 v50, v70, v50
    v_and_b32 v51, v70, v51
    v_and_b32 v52, v70, v52
    v_and_b32 v53, v70, v53
    v_and_b32 v54, v70, v54
    v_and_b32 v55, v70, v55
    v_mfma_f32_16x16x32_bf16 v[104:107], v[136:139], v[40:43], v[104:107]
    v_mfma_f32_16x16x32_bf16 v[76:79], v[140:143], v[44:47], v[76:79]
    v_and_b32 v56, v70, v56
    v_and_b32 v57, v70, v57
    v_and_b32 v58, v70, v58
    v_and_b32 v59, v70, v59
    v_and_b32 v60, v70, v60
    v_and_b32 v61, v70, v61
    v_and_b32 v62, v70, v62
    v_and_b32 v63, v70, v63
    v_mfma_f32_16x16x32_bf16 v[104:107], v[144:147], v[48:51], v[104:107]
    v_mfma_f32_16x16x32_bf16 v[76:79], v[148:151], v[52:55], v[76:79]
    v_mfma_f32_16x16x32_bf16 v[104:107], v[152:155], v[56:59], v[104:107]
    v_mfma_f32_16x16x32_bf16 v[76:79], v[156:159], v[60:63], v[76:79]
    s_nop 7
    v_pk_add_f32 v[104:105], v[104:105], v[76:77]
    v_pk_add_f32 v[106:107], v[106:107], v[78:79]
    v_cvt_pk_bf16_f32 v108, v104, v105
    v_cvt_pk_bf16_f32 v109, v106, v107
    s_mov_b32 exec_lo, -1
    s_mov_b32 exec_hi, 0
    ds_write_b64 v101, v[108:109] offset:0
    s_mov_b64 exec, -1
    s_branch e1done_49
e1other_48:
    v_lshlrev_b32 v17, 11, v10
    v_lshl_add_u32 v17, v11, 4, v17
    s_lshl_b32 s36, s32, 13
    s_lshl_b32 s37, s39, 9
    s_add_u32 s36, s36, s37
    s_lshr_b32 s37, s33, 1
    s_lshl_b32 s37, s37, 8
    s_add_u32 s36, s36, s37
    s_add_u32 s76, s36, 0xb00000
    s_lshl_b32 s36, s34, 2
    s_and_b32 s37, s33, 3
    s_add_u32 s36, s36, s37
    s_lshr_b32 s67, s36, 3
    s_bfe_u32 s68, s36, 0x20001
    s_and_b32 s69, s36, 1
    v_lshlrev_b32 v18, 13, v10
    v_lshl_add_u32 v18, v11, 4, v18
    s_lshl_b32 s36, s67, 11
    s_lshl_b32 s37, s68, 9
    s_add_u32 s36, s36, s37
    s_lshl_b32 s37, s69, 8
    s_add_u32 s36, s36, s37
    s_add_u32 s78, s36, 0xc00000
    s_mov_b32 s48, s26
    s_and_b32 s49, s27, 0xffff
    s_mov_b32 s50, 0x2000
    s_mov_b32 s51, 0x20000
    s_lshl_b32 s36, s68, 11
    s_lshl_b32 s37, s67, 8
    s_add_u32 s36, s36, s37
    s_lshl_b32 s37, s69, 7
    s_add_u32 s36, s36, s37
    s_add_u32 s79, s36, 0
    v_lshlrev_b32 v19, 3, v11
e1done_49:
    s_nop 4
    s_waitcnt vmcnt(0) lgkmcnt(0)
    s_barrier
    ds_read_b64 v[100:101], v99 offset:0
    ds_read_b64 v[102:103], v99 offset:512
    s_waitcnt lgkmcnt(0)
    v_perm_b32 v152, v100, v100, v2
    v_perm_b32 v153, v100, v100, v4
    v_perm_b32 v154, v100, v100, v6
    v_perm_b32 v155, v100, v100, v8
    v_perm_b32 v156, v102, v102, v2
    v_perm_b32 v157, v102, v102, v4
    v_perm_b32 v158, v102, v102, v6
    v_perm_b32 v159, v102, v102, v8
    v_perm_b32 v160, v100, v100, v3
    v_perm_b32 v161, v100, v100, v5
    v_perm_b32 v162, v100, v100, v7
    v_perm_b32 v163, v100, v100, v9
    v_perm_b32 v164, v102, v102, v3
    v_perm_b32 v165, v102, v102, v5
    v_perm_b32 v166, v102, v102, v7
    v_perm_b32 v167, v102, v102, v9
    v_perm_b32 v168, v101, v101, v2
    v_perm_b32 v169, v101, v101, v4
    v_perm_b32 v170, v101, v101, v6
    v_perm_b32 v171, v101, v101, v8
    v_perm_b32 v172, v103, v103, v2
    v_perm_b32 v173, v103, v103, v4
    v_perm_b32 v174, v103, v103, v6
    v_perm_b32 v175, v103, v103, v8
    v_perm_b32 v176, v101, v101, v3
    v_perm_b32 v177, v101, v101, v5
    v_perm_b32 v178, v101, v101, v7
    v_perm_b32 v179, v101, v101, v9
    v_perm_b32 v180, v103, v103, v3
    v_perm_b32 v181, v103, v103, v5
    v_perm_b32 v182, v103, v103, v7
    v_perm_b32 v183, v103, v103, v9
    v_mfma_f32_16x16x32_bf16 v[104:107], v[152:155], v[208:211], 0
    v_mfma_f32_16x16x32_bf16 v[108:111], v[156:159], v[208:211], 0
    v_mfma_f32_16x16x32_bf16 v[104:107], v[160:163], v[212:215], v[104:107]
    v_mfma_f32_16x16x32_bf16 v[108:111], v[164:167], v[212:215], v[108:111]
    v_mfma_f32_16x16x32_bf16 v[104:107], v[168:171], v[216:219], v[104:107]
    v_mfma_f32_16x16x32_bf16 v[108:111], v[172:175], v[216:219], v[108:111]
    v_mfma_f32_16x16x32_bf16 v[104:107], v[176:179], v[220:223], v[104:107]
    v_mfma_f32_16x16x32_bf16 v[108:111], v[180:183], v[220:223], v[108:111]
    s_nop 6
    ds_write_b128 v97, v[104:107] offset:2048
    ds_write_b128 v97, v[108:111] offset:3584
    s_waitcnt lgkmcnt(0)
    s_barrier
    s_cmp_ge_u32 s3, 4
    s_cbranch_scc1 hop25_67
    s_cmp_ge_u32 s3, 2
    s_cbranch_scc1 e2done_66w
    ds_read_b128 v[48:51], v95 offset:2048
    ds_read_b128 v[52:55], v95 offset:5120
    ds_read_b128 v[56:59], v95 offset:8192
    ds_read_b128 v[60:63], v95 offset:11264
    ds_read_b128 v[64:67], v95 offset:14336
    ds_read_b128 v[68:71], v95 offset:17408
    ds_read_b128 v[72:75], v95 offset:20480
    ds_read_b128 v[76:79], v95 offset:23552
    v_mov_b32 v82, v16
    v_mov_b32 v83, 0
    s_waitcnt lgkmcnt(4)
    v_pk_add_f32 v[48:49], v[48:49], v[52:53]
    v_pk_add_f32 v[50:51], v[50:51], v[54:55]
    v_pk_add_f32 v[56:57], v[56:57], v[60:61]
    v_pk_add_f32 v[58:59], v[58:59], v[62:63]
    v_pk_add_f32 v[48:49], v[48:49], v[56:57]
    v_pk_add_f32 v[50:51], v[50:51], v[58:59]
    s_waitcnt lgkmcnt(0)
    v_pk_add_f32 v[64:65], v[64:65], v[68:69]
    v_pk_add_f32 v[66:67], v[66:67], v[70:71]
    v_pk_add_f32 v[72:73], v[72:73], v[76:77]
    v_pk_add_f32 v[74:75], v[74:75], v[78:79]
    v_pk_add_f32 v[64:65], v[64:65], v[72:73]
    v_pk_add_f32 v[66:67], v[66:67], v[74:75]
    v_pk_add_f32 v[48:49], v[48:49], v[64:65]
    v_pk_add_f32 v[50:51], v[50:51], v[66:67]
    v_cvt_pk_bf16_f32 v80, v48, v49
    v_cvt_pk_bf16_f32 v81, v50, v51
    buffer_store_dwordx4 v[80:83], v98, s[44:47], s40 offen sc1
e2done_66w:
    s_nop 3
    s_barrier
    s_mov_b32 s52, s14
    s_and_b32 s53, s15, 0xffff
    s_mov_b32 s54, 0x400000
    s_mov_b32 s55, 0x20000
    v_lshlrev_b32 v245, 14, v10
    v_lshl_add_u32 v245, v11, 4, v245
    s_lshl_b32 s36, s72, 6
    s_lshl_b32 s37, s3, 1
    s_add_u32 s36, s36, s37
    s_lshl_b32 s36, s36, 10
    s_lshl_b32 s38, s73, 9
    s_add_u32 s36, s36, s38
    buffer_load_dwordx4 v[224:227], v245, s[52:55], s36 offen offset:0 nt
    buffer_load_dwordx4 v[228:231], v245, s[52:55], s36 offen offset:1024 nt
    buffer_load_dwordx4 v[232:235], v245, s[52:55], s36 offen offset:256 nt
    buffer_load_dwordx4 v[236:239], v245, s[52:55], s36 offen offset:1280 nt
    s_branch e2done_66
hop25_67:
    s_barrier
    s_mov_b32 s52, s14
    s_and_b32 s53, s15, 0xffff
    s_mov_b32 s54, 0x400000
    s_mov_b32 s55, 0x20000
    v_lshlrev_b32 v245, 14, v10
    v_lshl_add_u32 v245, v11, 4, v245
    s_lshl_b32 s36, s72, 6
    s_lshl_b32 s37, s3, 1
    s_add_u32 s36, s36, s37
    s_lshl_b32 s36, s36, 10
    s_lshl_b32 s38, s73, 9
    s_add_u32 s36, s36, s38
    buffer_load_dwordx4 v[224:227], v245, s[52:55], s36 offen offset:0 nt
    buffer_load_dwordx4 v[228:231], v245, s[52:55], s36 offen offset:1024 nt
    buffer_load_dwordx4 v[232:235], v245, s[52:55], s36 offen offset:256 nt
    buffer_load_dwordx4 v[236:239], v245, s[52:55], s36 offen offset:1280 nt
    s_mov_b32 s42, 0
poll_68:
    buffer_load_dwordx4 v[128:131], v17, s[44:47], s76 offen sc1
    s_add_u32 s42, s42, 1
    s_waitcnt vmcnt(0)
    v_cmp_ne_u32 s[74:75], s70, v130
    s_cmp_eq_u64 s[74:75], 0
    s_cbranch_scc1 polld_69
    s_sleep 3
    s_cmp_lt_u32 s42, 0x20000
    s_cbranch_scc1 poll_68
polld_69:
    v_mfma_f32_16x16x32_bf16 v[40:43], v[12:15], v[128:131], 0
    s_nop 7
    v_cvt_pk_bf16_f32 v44, v40, v41
    v_cvt_pk_bf16_f32 v45, v42, v43
    s_mov_b64 exec, 0xffff
    ds_write_b64 v112, v[44:45] offset:1024
    s_mov_b64 exec, -1
e2done_66:
    s_nop 1
    s_lshl_b32 s41, s72, 2
    s_lshl_b32 s36, s73, 1
    s_add_u32 s41, s41, s36
    s_lshl_b32 s41, s41, 11
    s_add_u32 s41, s41, 0xc00000
    s_waitcnt vmcnt(0) lgkmcnt(0)
    s_barrier
    ds_read_b32 v100, v96 offset:1024
    ds_read_b32 v101, v96 offset:1280
    s_waitcnt lgkmcnt(0)
    v_perm_b32 v152, v100, v100, v2
    v_perm_b32 v153, v100, v100, v4
    v_perm_b32 v154, v100, v100, v6
    v_perm_b32 v155, v100, v100, v8
    v_perm_b32 v156, v101, v101, v2
    v_perm_b32 v157, v101, v101, v4
    v_perm_b32 v158, v101, v101, v6
    v_perm_b32 v159, v101, v101, v8
    v_perm_b32 v160, v100, v100, v3
    v_perm_b32 v161, v100, v100, v5
    v_perm_b32 v162, v100, v100, v7
    v_perm_b32 v163, v100, v100, v9
    v_perm_b32 v164, v101, v101, v3
    v_perm_b32 v165, v101, v101, v5
    v_perm_b32 v166, v101, v101, v7
    v_perm_b32 v167, v101, v101, v9
    v_mfma_f32_16x16x32_bf16 v[104:107], v[152:155], v[224:227], 0
    v_mfma_f32_16x16x32_bf16 v[108:111], v[156:159], v[224:227], 0
    v_mfma_f32_16x16x32_bf16 v[112:115], v[152:155], v[232:235], 0
    v_mfma_f32_16x16x32_bf16 v[116:119], v[156:159], v[232:235], 0
    v_mfma_f32_16x16x32_bf16 v[104:107], v[160:163], v[228:231], v[104:107]
    v_mfma_f32_16x16x32_bf16 v[108:111], v[164:167], v[228:231], v[108:111]
    v_mfma_f32_16x16x32_bf16 v[112:115], v[160:163], v[236:239], v[112:115]
    v_mfma_f32_16x16x32_bf16 v[116:119], v[164:167], v[236:239], v[116:119]
    s_nop 4
    ds_write_b128 v97, v[104:107] offset:2048
    ds_write_b128 v97, v[108:111] offset:3584
    ds_write_b128 v97, v[112:115] offset:26624
    ds_write_b128 v97, v[116:119] offset:28160
    s_waitcnt lgkmcnt(0)
    s_barrier
    s_cmp_ge_u32 s3, 4
    s_cbranch_scc1 fin_70
    s_cmp_ge_u32 s3, 2
    s_cbranch_scc1 pub2_72
    ds_read_b128 v[48:51], v95 offset:2048
    ds_read_b128 v[52:55], v95 offset:5120
    ds_read_b128 v[56:59], v95 offset:8192
    ds_read_b128 v[60:63], v95 offset:11264
    ds_read_b128 v[64:67], v95 offset:14336
    ds_read_b128 v[68:71], v95 offset:17408
    ds_read_b128 v[72:75], v95 offset:20480
    ds_read_b128 v[76:79], v95 offset:23552
    v_mov_b32 v82, v16
    v_mov_b32 v83, 0
    s_waitcnt lgkmcnt(4)
    v_pk_add_f32 v[48:49], v[48:49], v[52:53]
    v_pk_add_f32 v[50:51], v[50:51], v[54:55]
    v_pk_add_f32 v[56:57], v[56:57], v[60:61]
    v_pk_add_f32 v[58:59], v[58:59], v[62:63]
    v_pk_add_f32 v[48:49], v[48:49], v[56:57]
    v_pk_add_f32 v[50:51], v[50:51], v[58:59]
    s_waitcnt lgkmcnt(0)
    v_pk_add_f32 v[64:65], v[64:65], v[68:69]
    v_pk_add_f32 v[66:67], v[66:67], v[70:71]
    v_pk_add_f32 v[72:73], v[72:73], v[76:77]
    v_pk_add_f32 v[74:75], v[74:75], v[78:79]
    v_pk_add_f32 v[64:65], v[64:65], v[72:73]
    v_pk_add_f32 v[66:67], v[66:67], v[74:75]
    v_pk_add_f32 v[48:49], v[48:49], v[64:65]
    v_pk_add_f32 v[50:51], v[50:51], v[66:67]
    v_cvt_pk_bf16_f32 v80, v48, v49
    v_cvt_pk_bf16_f32 v81, v50, v51
    buffer_store_dwordx4 v[80:83], v98, s[44:47], s41 offen sc1
    s_branch tail_end_71
pub2_72:
    s_nop 2
    s_add_u32 s36, s41, 2048
    ds_read_b128 v[48:51], v95 offset:26624
    ds_read_b128 v[52:55], v95 offset:29696
    ds_read_b128 v[56:59], v95 offset:32768
    ds_read_b128 v[60:63], v95 offset:35840
    ds_read_b128 v[64:67], v95 offset:38912
    ds_read_b128 v[68:71], v95 offset:41984
    ds_read_b128 v[72:75], v95 offset:45056
    ds_read_b128 v[76:79], v95 offset:48128
    v_mov_b32 v82, v16
    v_mov_b32 v83, 0
    s_waitcnt lgkmcnt(4)
    v_pk_add_f32 v[48:49], v[48:49], v[52:53]
    v_pk_add_f32 v[50:51], v[50:51], v[54:55]
    v_pk_add_f32 v[56:57], v[56:57], v[60:61]
    v_pk_add_f32 v[58:59], v[58:59], v[62:63]
    v_pk_add_f32 v[48:49], v[48:49], v[56:57]
    v_pk_add_f32 v[50:51], v[50:51], v[58:59]
    s_waitcnt lgkmcnt(0)
    v_pk_add_f32 v[64:65], v[64:65], v[68:69]
    v_pk_add_f32 v[66:67], v[66:67], v[70:71]
    v_pk_add_f32 v[72:73], v[72:73], v[76:77]
    v_pk_add_f32 v[74:75], v[74:75], v[78:79]
    v_pk_add_f32 v[64:65], v[64:65], v[72:73]
    v_pk_add_f32 v[66:67], v[66:67], v[74:75]
    v_pk_add_f32 v[48:49], v[48:49], v[64:65]
    v_pk_add_f32 v[50:51], v[50:51], v[66:67]
    v_cvt_pk_bf16_f32 v80, v48, v49
    v_cvt_pk_bf16_f32 v81, v50, v51
    buffer_store_dwordx4 v[80:83], v98, s[44:47], s36 offen sc1
    s_branch tail_end_71
fin_70:
    s_nop 2
    s_cmp_lg_u32 s3, 4
    s_cbranch_scc1 tail_end_71
    s_and_b32 s36, s35, 3
    s_cmp_lg_u32 s36, 0
    s_cbranch_scc1 tail_end_71
    s_mov_b32 s42, 0
    s_sleep 10
    s_add_u32 s37, s78, 0
    buffer_load_dwordx4 v[32:35], v18, s[44:47], s37 offen sc1
    s_add_u32 s37, s78, 32768
    buffer_load_dwordx4 v[36:39], v18, s[44:47], s37 offen sc1
    s_add_u32 s37, s78, 65536
    buffer_load_dwordx4 v[40:43], v18, s[44:47], s37 offen sc1
    s_add_u32 s37, s78, 98304
    buffer_load_dwordx4 v[44:47], v18, s[44:47], s37 offen sc1
    s_add_u32 s37, s78, 131072
    buffer_load_dwordx4 v[48:51], v18, s[44:47], s37 offen sc1
    s_add_u32 s37, s78, 163840
    buffer_load_dwordx4 v[52:55], v18, s[44:47], s37 offen sc1
    s_add_u32 s37, s78, 196608
    buffer_load_dwordx4 v[56:59], v18, s[44:47], s37 offen sc1
    s_add_u32 s37, s78, 229376
    buffer_load_dwordx4 v[60:63], v18, s[44:47], s37 offen sc1
    s_add_u32 s37, s78, 262144
    buffer_load_dwordx4 v[64:67], v18, s[44:47], s37 offen sc1
    s_add_u32 s37, s78, 294912
    buffer_load_dwordx4 v[68:71], v18, s[44:47], s37 offen sc1
    s_add_u32 s37, s78, 327680
    buffer_load_dwordx4 v[72:75], v18, s[44:47], s37 offen sc1
    s_add_u32 s37, s78, 360448
    buffer_load_dwordx4 v[76:79], v18, s[44:47], s37 offen sc1
    s_add_u32 s37, s78, 393216
    buffer_load_dwordx4 v[80:83], v18, s[44:47], s37 offen sc1
    s_add_u32 s37, s78, 425984
    buffer_load_dwordx4 v[84:87], v18, s[44:47], s37 offen sc1
    s_add_u32 s37, s78, 458752
    buffer_load_dwordx4 v[88:91], v18, s[44:47], s37 offen sc1
    s_add_u32 s37, s78, 491520
    buffer_load_dwordx4 v[92:95], v18, s[44:47], s37 offen sc1
pm_73:
    s_waitcnt vmcnt(0)
    v_xor_b32 v96, v34, v16
    v_bitop3_b32 v96, v38, v16, v96 bitop3:0xbe
    v_bitop3_b32 v96, v42, v16, v96 bitop3:0xbe
    v_bitop3_b32 v96, v46, v16, v96 bitop3:0xbe
    v_bitop3_b32 v96, v50, v16, v96 bitop3:0xbe
    v_bitop3_b32 v96, v54, v16, v96 bitop3:0xbe
    v_bitop3_b32 v96, v58, v16, v96 bitop3:0xbe
    v_bitop3_b32 v96, v62, v16, v96 bitop3:0xbe
    v_bitop3_b32 v96, v66, v16, v96 bitop3:0xbe
    v_bitop3_b32 v96, v70, v16, v96 bitop3:0xbe
    v_bitop3_b32 v96, v74, v16, v96 bitop3:0xbe
    v_bitop3_b32 v96, v78, v16, v96 bitop3:0xbe
    v_bitop3_b32 v96, v82, v16, v96 bitop3:0xbe
    v_bitop3_b32 v96, v86, v16, v96 bitop3:0xbe
    v_bitop3_b32 v96, v90, v16, v96 bitop3:0xbe
    v_bitop3_b32 v96, v94, v16, v96 bitop3:0xbe
    v_cmp_ne_u32 vcc, 0, v96
    s_cbranch_vccz pmd_74
    s_mov_b32 s74, 0
    v_cmp_ne_u32 vcc, s70, v34
    s_cbranch_vccz pms_75
    s_add_u32 s37, s78, 0
    buffer_load_dwordx4 v[32:35], v18, s[44:47], s37 offen sc1
    s_mov_b32 s74, 1
pms_75:
    v_cmp_ne_u32 vcc, s70, v38
    s_cbranch_vccz pms_76
    s_add_u32 s37, s78, 32768
    buffer_load_dwordx4 v[36:39], v18, s[44:47], s37 offen sc1
    s_mov_b32 s74, 1
pms_76:
    v_cmp_ne_u32 vcc, s70, v42
    s_cbranch_vccz pms_77
    s_add_u32 s37, s78, 65536
    buffer_load_dwordx4 v[40:43], v18, s[44:47], s37 offen sc1
    s_mov_b32 s74, 1
pms_77:
    v_cmp_ne_u32 vcc, s70, v46
    s_cbranch_vccz pms_78
    s_add_u32 s37, s78, 98304
    buffer_load_dwordx4 v[44:47], v18, s[44:47], s37 offen sc1
    s_mov_b32 s74, 1
pms_78:
    v_cmp_ne_u32 vcc, s70, v50
    s_cbranch_vccz pms_79
    s_add_u32 s37, s78, 131072
    buffer_load_dwordx4 v[48:51], v18, s[44:47], s37 offen sc1
    s_mov_b32 s74, 1
pms_79:
    v_cmp_ne_u32 vcc, s70, v54
    s_cbranch_vccz pms_80
    s_add_u32 s37, s78, 163840
    buffer_load_dwordx4 v[52:55], v18, s[44:47], s37 offen sc1
    s_mov_b32 s74, 1
pms_80:
    v_cmp_ne_u32 vcc, s70, v58
    s_cbranch_vccz pms_81
    s_add_u32 s37, s78, 196608
    buffer_load_dwordx4 v[56:59], v18, s[44:47], s37 offen sc1
    s_mov_b32 s74, 1
pms_81:
    v_cmp_ne_u32 vcc, s70, v62
    s_cbranch_vccz pms_82
    s_add_u32 s37, s78, 229376
    buffer_load_dwordx4 v[60:63], v18, s[44:47], s37 offen sc1
    s_mov_b32 s74, 1
pms_82:
    v_cmp_ne_u32 vcc, s70, v66
    s_cbranch_vccz pms_83
    s_add_u32 s37, s78, 262144
    buffer_load_dwordx4 v[64:67], v18, s[44:47], s37 offen sc1
    s_mov_b32 s74, 1
pms_83:
    v_cmp_ne_u32 vcc, s70, v70
    s_cbranch_vccz pms_84
    s_add_u32 s37, s78, 294912
    buffer_load_dwordx4 v[68:71], v18, s[44:47], s37 offen sc1
    s_mov_b32 s74, 1
pms_84:
    v_cmp_ne_u32 vcc, s70, v74
    s_cbranch_vccz pms_85
    s_add_u32 s37, s78, 327680
    buffer_load_dwordx4 v[72:75], v18, s[44:47], s37 offen sc1
    s_mov_b32 s74, 1
pms_85:
    v_cmp_ne_u32 vcc, s70, v78
    s_cbranch_vccz pms_86
    s_add_u32 s37, s78, 360448
    buffer_load_dwordx4 v[76:79], v18, s[44:47], s37 offen sc1
    s_mov_b32 s74, 1
pms_86:
    v_cmp_ne_u32 vcc, s70, v82
    s_cbranch_vccz pms_87
    s_add_u32 s37, s78, 393216
    buffer_load_dwordx4 v[80:83], v18, s[44:47], s37 offen sc1
    s_mov_b32 s74, 1
pms_87:
    v_cmp_ne_u32 vcc, s70, v86
    s_cbranch_vccz pms_88
    s_add_u32 s37, s78, 425984
    buffer_load_dwordx4 v[84:87], v18, s[44:47], s37 offen sc1
    s_mov_b32 s74, 1
pms_88:
    v_cmp_ne_u32 vcc, s70, v90
    s_cbranch_vccz pms_89
    s_add_u32 s37, s78, 458752
    buffer_load_dwordx4 v[88:91], v18, s[44:47], s37 offen sc1
    s_mov_b32 s74, 1
pms_89:
    v_cmp_ne_u32 vcc, s70, v94
    s_cbranch_vccz pms_90
    s_add_u32 s37, s78, 491520
    buffer_load_dwordx4 v[92:95], v18, s[44:47], s37 offen sc1
    s_mov_b32 s74, 1
pms_90:
    s_cmp_eq_u32 s74, 0
    s_cbranch_scc1 pmd_74
    s_add_u32 s42, s42, 1
    s_sleep 2
    s_cmp_lt_u32 s42, 0x20000
    s_cbranch_scc1 pm_73
    s_waitcnt vmcnt(0)
pmd_74:
    v_mfma_f32_16x16x32_bf16 v[100:103], v[12:15], v[32:35], 0
    v_mfma_f32_16x16x32_bf16 v[104:107], v[12:15], v[36:39], 0
    v_mfma_f32_16x16x32_bf16 v[108:111], v[12:15], v[40:43], 0
    v_mfma_f32_16x16x32_bf16 v[112:115], v[12:15], v[44:47], 0
    v_mfma_f32_16x16x32_bf16 v[100:103], v[12:15], v[48:51], v[100:103]
    v_mfma_f32_16x16x32_bf16 v[104:107], v[12:15], v[52:55], v[104:107]
    v_mfma_f32_16x16x32_bf16 v[108:111], v[12:15], v[56:59], v[108:111]
    v_mfma_f32_16x16x32_bf16 v[112:115], v[12:15], v[60:63], v[112:115]
    v_mfma_f32_16x16x32_bf16 v[100:103], v[12:15], v[64:67], v[100:103]
    v_mfma_f32_16x16x32_bf16 v[104:107], v[12:15], v[68:71], v[104:107]
    v_mfma_f32_16x16x32_bf16 v[108:111], v[12:15], v[72:75], v[108:111]
    v_mfma_f32_16x16x32_bf16 v[112:115], v[12:15], v[76:79], v[112:115]
    v_mfma_f32_16x16x32_bf16 v[100:103], v[12:15], v[80:83], v[100:103]
    v_mfma_f32_16x16x32_bf16 v[104:107], v[12:15], v[84:87], v[104:107]
    v_mfma_f32_16x16x32_bf16 v[108:111], v[12:15], v[88:91], v[108:111]
    v_mfma_f32_16x16x32_bf16 v[112:115], v[12:15], v[92:95], v[112:115]
    s_nop 5
    v_pk_add_f32 v[100:101], v[100:101], v[104:105]
    s_nop 0
    v_pk_add_f32 v[108:109], v[108:109], v[112:113]
    v_pk_add_f32 v[102:103], v[102:103], v[106:107]
    v_pk_add_f32 v[110:111], v[110:111], v[114:115]
    v_pk_add_f32 v[100:101], v[100:101], v[108:109]
    v_pk_add_f32 v[102:103], v[102:103], v[110:111]
    v_cvt_pk_bf16_f32 v108, v100, v101
    v_cvt_pk_bf16_f32 v109, v102, v103
    s_mov_b64 exec, 0xffff
    buffer_store_dwordx2 v[108:109], v19, s[48:51], s79 offen
    s_cmp_lg_u32 s2, 0
    s_cbranch_scc1 tail_end_71
    s_mov_b64 exec, 1
    v_mov_b32 v17, 0
    v_mov_b32 v18, s71
    buffer_store_dword v18, v17, s[44:47], 0 offen sc1
tail_end_71:
    s_nop 3
    s_mov_b64 exec, -1
allend_4:
L_end:
    s_endpgm
.section .rodata,"a"
.p2align 6
.amdhsa_kernel concat_heads__compressed_kv_cla__sliding_block_cached__decode_kernel
  .amdhsa_next_free_vgpr 256
  .amdhsa_next_free_sgpr 102
  .amdhsa_accum_offset 256
  .amdhsa_group_segment_fixed_size 0
  .amdhsa_kernarg_size 112
  .amdhsa_user_sgpr_count 2
  .amdhsa_user_sgpr_kernarg_segment_ptr 1
  .amdhsa_system_sgpr_workgroup_id_x 1
  .amdhsa_float_denorm_mode_32 3
.end_amdhsa_kernel
```
